```python
import torch

def _softmax(x, axis=-1):
    return torch.softmax(x, dim=axis)
def _gelu(x):
    return torch.nn.functional.gelu(x, approximate="tanh")
def _silu(x):
    return torch.nn.functional.silu(x)
def _sigmoid(x):
    return torch.sigmoid(x)
def _layernorm(x, axis=-1, eps=1e-5):
    m = x.mean(dim=axis, keepdim=True)
    v = x.var(dim=axis, keepdim=True, unbiased=False)
    return (x - m) / torch.sqrt(v + eps)
def _scatter_add(tgt, idx, src, axis=0):
    return tgt.clone().index_add_(axis, idx, src)
def _segment_sum(src, seg, n):
    out = torch.zeros((n,) + src.shape[1:], dtype=src.dtype)
    return out.index_add_(0, seg, src)
def _pad(x, pw):
    flat = tuple(v for pair in reversed(pw) for v in pair)
    return torch.nn.functional.pad(x, flat)

kernel_name = 'parallel_sum__mha_block__glu_gated_swiglu__prompt'

def setup_inputs():

    _w = (lambda a: (lambda t: t.to(torch.bfloat16) if t.is_floating_point() else t)(torch.as_tensor(a)))
    def _A_setup():
        B, S, D, H = 1, 2048, 512, 32
        return {
            "x": _w((lambda *s: torch.randn(*s, dtype=torch.bfloat16) * 0.05)(B, S, D)),
            "wqkv": _w((lambda *s: torch.randn(*s, dtype=torch.bfloat16) * 0.05)(D, 3 * D)),
            "wo": _w((lambda *s: torch.randn(*s, dtype=torch.bfloat16) * 0.05)(D, D)),
        }
    _A_in = _A_setup()

    def _B_setup():
        B, S, D, F = 1, 2048, 512, 1376
        return {
            "x": _w((lambda *s: torch.randn(*s, dtype=torch.bfloat16) * 0.05)(B, S, D)),
            "w1": _w((lambda *s: torch.randn(*s, dtype=torch.bfloat16) * 0.4)(D, F) * (2.0 / D) ** 0.5),
            "w3": _w((lambda *s: torch.randn(*s, dtype=torch.bfloat16) * 0.4)(D, F) * (2.0 / D) ** 0.5),
            "w2": _w((lambda *s: torch.randn(*s, dtype=torch.bfloat16) * 0.4)(F, D) * (2.0 / F) ** 0.5),
        }
    _B_in = _B_setup()

    return {
        "A_x": _A_in["x"],
        "A_wqkv": _A_in["wqkv"],
        "A_wo": _A_in["wo"],
        "B_x": _B_in["x"],
        "B_w1": _B_in["w1"],
        "B_w3": _B_in["w3"],
        "B_w2": _B_in["w2"],
    }

def reference(A_x, A_wqkv, A_wo, B_x, B_w1, B_w3, B_w2):
    def _A_ref(x, wqkv, wo):
        B, S, D = x.shape
        H = 32
        Dh = D // H
        qkv = (lambda x, *d: x.permute(*d))((x @ wqkv).reshape(B, S, 3, H, Dh), 2, 0, 3, 1, 4)
        q, k, v = qkv[0], qkv[1], qkv[2]
        scores = torch.einsum("bhqd,bhkd->bhqk", q, k) * (Dh ** -0.5)
        p = _softmax(scores, axis=-1)
        o = torch.einsum("bhqk,bhkd->bhqd", p, v)
        return (lambda x, *d: x.permute(*d))(o, 0, 2, 1, 3).reshape(B, S, D) @ wo

    def _B_ref(x, w1, w3, w2):
        gate = torch.einsum("bsd,df->bsf", x, w1)
        up = torch.einsum("bsd,df->bsf", x, w3)
        h = _silu(gate) * up
        out = torch.einsum("bsf,fd->bsd", h, w2)
        return out

    x = A_x
    xn = _layernorm(x, axis=-1)
    return x + _A_ref(xn, A_wqkv, A_wo) + _B_ref(xn, B_w1, B_w3, B_w2)
```

```asm
; @launch grid=(256,1,1) block=(512,1,1) lds=159744
.amdgcn_target "amdgcn-amd-amdhsa--gfx950"
.text
.globl parallel_sum__mha_block__glu_gated_swiglu__prompt_kernel
.p2align 8
.type parallel_sum__mha_block__glu_gated_swiglu__prompt_kernel,@function
parallel_sum__mha_block__glu_gated_swiglu__prompt_kernel:
  s_cmp_ge_u32 s2, 256
  s_cbranch_scc1 L_end
  s_load_dwordx4 s[4:7], s[0:1], 0
  s_load_dwordx4 s[60:63], s[0:1], 32
  s_load_dwordx2 s[38:39], s[0:1], 48
  s_load_dwordx2 s[40:41], s[0:1], 16
  s_load_dwordx4 s[64:67], s[0:1], 56
  s_load_dwordx2 s[68:69], s[0:1], 72
  v_lshrrev_b32 v1, 6, v0
  v_and_b32 v0, 63, v0
  s_and_b32 s29, s2, 7
  v_readfirstlane_b32 s24, v1
  s_lshr_b32 s30, s2, 3
  s_and_b32 s31, s29, 1
  s_lshl_b32 s31, s31, 3
  s_and_b32 s32, s30, 7
  s_add_u32 s28, s31, s32
  s_lshr_b32 s31, s29, 1
  s_lshl_b32 s31, s31, 2
  s_lshr_b32 s33, s30, 3
  s_add_u32 s27, s31, s33
  s_lshl_b32 s31, s29, 2
  s_add_u32 s49, s31, s33
  s_mov_b32 s50, s32
  s_mov_b32 s58, s49
  s_mov_b32 s59, s32
  v_lshlrev_b32 v255, 4, v0
  v_mov_b32 v7, 0
  s_and_b32 s25, s24, 3
  s_lshr_b32 s26, s24, 2
  s_lshl_b32 s48, s28, 2
  s_add_u32 s48, s48, s25
  v_lshrrev_b32 v1, 3, v0
  s_lshl_b32 s29, s28, 7
  s_lshl_b32 s30, s25, 5
  s_add_u32 s29, s29, s30
  v_add_u32 v1, s29, v1
  v_lshlrev_b32 v1, 10, v1
  v_lshrrev_b32 v2, 4, v0
  v_and_b32 v3, 7, v0
  v_xor_b32 v4, v2, v3
  v_lshl_add_u32 v244, v4, 4, v1
  v_xor_b32 v4, 4, v4
  v_lshl_add_u32 v245, v4, 4, v1
  v_add_u32 v245, 8192, v245
  s_mul_i32 s31, s27, 192
  s_mul_i32 s29, s25, 49152
  s_add_u32 s35, s29, s31
  s_mov_b32 s32, 43691
  s_movk_i32 s33, 3072
  v_add_u32 v1, 0, v0
  v_mul_u32_u24 v2, s32, v1
  v_lshrrev_b32 v2, 19, v2
  v_mul_u32_u24 v3, 12, v2
  v_sub_u32 v3, v1, v3
  v_mul_u32_u24 v2, s33, v2
  v_lshl_add_u32 v246, v3, 4, v2
  v_add_u32 v1, 64, v0
  v_mul_u32_u24 v2, s32, v1
  v_lshrrev_b32 v2, 19, v2
  v_mul_u32_u24 v3, 12, v2
  v_sub_u32 v3, v1, v3
  v_mul_u32_u24 v2, s33, v2
  v_lshl_add_u32 v247, v3, 4, v2
  v_add_u32 v1, 128, v0
  v_mul_u32_u24 v2, s32, v1
  v_lshrrev_b32 v2, 19, v2
  v_mul_u32_u24 v3, 12, v2
  v_sub_u32 v3, v1, v3
  v_mul_u32_u24 v2, s33, v2
  v_lshl_add_u32 v248, v3, 4, v2
  s_mul_i32 s30, s25, 3072
  s_add_u32 s45, s30, 16384
  s_lshl_b32 s44, s25, 12
  s_waitcnt lgkmcnt(0)
  s_mov_b32 s8, s4
  s_mov_b32 s9, s5
  s_mov_b32 s10, 2097152
  s_mov_b32 s11, 0x20000
  s_mov_b32 s12, s6
  s_mov_b32 s13, s7
  s_mov_b32 s14, 1572864
  s_mov_b32 s15, 0x20000
  s_mov_b32 s42, 0
  s_cmp_eq_u32 s26, 0
  s_cbranch_scc0 L_uh1
  s_cmp_lg_u32 s25, 0
  s_cbranch_scc1 L_mpf_1
  s_mul_i32 s29, s2, 64
  v_add_u32 v1, s29, v0
  v_lshlrev_b32 v1, 7, v1
  buffer_load_dword v250, v1, s[8:11], 0 offen
  s_mov_b64 exec, -1
L_mpf_1:
  s_cmp_lg_u32 s25, 1
  s_cbranch_scc1 L_mpf_2
  s_mul_i32 s29, s2, 48
  v_add_u32 v1, s29, v0
  v_lshlrev_b32 v1, 7, v1
  s_mov_b32 s30, 0xffffffff
  s_mov_b32 s31, 0xffff
  s_mov_b64 exec, s[30:31]
  buffer_load_dword v250, v1, s[12:15], 0 offen
  s_mov_b64 exec, -1
L_mpf_2:
  s_cmp_lg_u32 s25, 2
  s_cbranch_scc1 L_cpf_3
  s_getpc_b64 s[30:31]
L_here_4:
  s_sub_u32 s30, s30, L_here_4-parallel_sum__mha_block__glu_gated_swiglu__prompt_kernel
  s_subb_u32 s31, s31, 0
  s_lshr_b32 s29, s2, 3
  s_mul_i32 s29, s29, 10
  v_add_u32 v1, s29, v0
  v_min_u32 v1, (L_end-parallel_sum__mha_block__glu_gated_swiglu__prompt_kernel)/128, v1
  v_lshlrev_b32 v1, 7, v1
  s_mov_b64 exec, 0x3ff
  global_load_dword v250, v1, s[30:31]
  s_mov_b64 exec, -1
L_cpf_3:
  s_mov_b32 s16, s60
  s_mov_b32 s17, s61
  s_mov_b32 s18, 1409024
  s_mov_b32 s19, 0x20000
  s_mov_b32 s20, s68
  s_mov_b32 s21, s69
  s_mov_b32 s22, 14024704
  s_mov_b32 s23, 0x20000
  s_mov_b32 s36, s64
  s_mov_b32 s37, s65
  s_mov_b32 s42, 0
  s_add_u32 s30, s68, 14036992
  s_addc_u32 s31, s69, 0
  s_load_dword s3, s[30:31], 0
  s_mov_b32 s4, s62
  s_mov_b32 s5, s63
  s_mov_b32 s6, 1409024
  s_mov_b32 s7, 0x20000
  s_movk_i32 s33, 2752
  s_mov_b32 s32, 43691
  v_add_u32 v1, 0, v0
  v_mul_u32_u24 v2, s32, v1
  v_lshrrev_b32 v2, 19, v2
  v_mul_u32_u24 v3, 12, v2
  v_sub_u32 v3, v1, v3
  v_mov_b32 v4, v3
  v_mul_u32_u24 v2, s33, v2
  v_lshl_add_u32 v232, v4, 4, v2
  v_lshrrev_b32 v3, 2, v3
  s_mul_i32 s29, s27, 3
  v_add_u32 v3, s29, v3
  v_cmp_lt_u32 vcc, 42, v3
  v_mov_b32 v2, 0x7ff00000
  s_nop 0
  v_cndmask_b32 v232, v232, v2, vcc
  v_add_u32 v1, 64, v0
  v_mul_u32_u24 v2, s32, v1
  v_lshrrev_b32 v2, 19, v2
  v_mul_u32_u24 v3, 12, v2
  v_sub_u32 v3, v1, v3
  v_mov_b32 v4, v3
  v_mul_u32_u24 v2, s33, v2
  v_lshl_add_u32 v233, v4, 4, v2
  v_lshrrev_b32 v3, 2, v3
  s_mul_i32 s29, s27, 3
  v_add_u32 v3, s29, v3
  v_cmp_lt_u32 vcc, 42, v3
  v_mov_b32 v2, 0x7ff00000
  s_nop 0
  v_cndmask_b32 v233, v233, v2, vcc
  v_add_u32 v1, 128, v0
  v_mul_u32_u24 v2, s32, v1
  v_lshrrev_b32 v2, 19, v2
  v_mul_u32_u24 v3, 12, v2
  v_sub_u32 v3, v1, v3
  v_mov_b32 v4, v3
  v_mul_u32_u24 v2, s33, v2
  v_lshl_add_u32 v234, v4, 4, v2
  v_lshrrev_b32 v3, 2, v3
  s_mul_i32 s29, s27, 3
  v_add_u32 v3, s29, v3
  v_cmp_lt_u32 vcc, 42, v3
  v_mov_b32 v2, 0x7ff00000
  s_nop 0
  v_cndmask_b32 v234, v234, v2, vcc
  s_mul_i32 s31, s27, 192
  s_mul_i32 s46, s25, 3072
  s_mul_i32 s29, s25, 44032
  s_add_u32 s47, s29, s31
  v_and_b32 v1, 31, v0
  v_lshrrev_b32 v2, 5, v0
  s_lshl_b32 s29, s25, 5
  v_add_u32 v3, s29, v1
  v_lshlrev_b32 v3, 7, v3
  v_lshlrev_b32 v4, 2, v2
  v_or_b32 v4, s25, v4
  v_bfe_u32 v5, v1, 1, 3
  v_xor_b32 v4, v4, v5
  v_lshl_add_u32 v240, v4, 4, v3
  v_xor_b32 v241, 16, v240
  v_xor_b32 v242, 32, v240
  v_xor_b32 v243, 48, v240
  v_lshlrev_b32 v3, 5, v2
  v_bfe_u32 v4, v0, 2, 2
  v_add_u32 v3, v3, v4
  v_mul_u32_u24 v3, 0xc0, v3
  v_bfe_u32 v4, v0, 4, 1
  v_lshl_add_u32 v3, v4, 5, v3
  v_and_b32 v4, 3, v0
  v_lshl_add_u32 v3, v4, 3, v3
  s_xor_b32 s29, s25, 0
  s_mul_i32 s29, s29, 1536
  v_add_u32 v236, s29, v3
  s_xor_b32 s29, s25, 1
  s_mul_i32 s29, s29, 1536
  v_add_u32 v237, s29, v3
  s_xor_b32 s29, s25, 2
  s_mul_i32 s29, s29, 1536
  v_add_u32 v238, s29, v3
  s_xor_b32 s29, s25, 3
  s_mul_i32 s29, s29, 1536
  v_add_u32 v239, s29, v3
  s_mov_b32 s34, 0xffff0000
  v_mov_b32 v136, 0
  v_mov_b32 v137, 0
  v_mov_b32 v138, 0
  v_mov_b32 v139, 0
  v_mov_b32 v140, 0
  v_mov_b32 v141, 0
  v_mov_b32 v142, 0
  v_mov_b32 v143, 0
  v_mov_b32 v144, 0
  v_mov_b32 v145, 0
  v_mov_b32 v146, 0
  v_mov_b32 v147, 0
  v_mov_b32 v148, 0
  v_mov_b32 v149, 0
  v_mov_b32 v150, 0
  v_mov_b32 v151, 0
  v_mov_b32 v152, 0
  v_mov_b32 v153, 0
  v_mov_b32 v154, 0
  v_mov_b32 v155, 0
  v_mov_b32 v156, 0
  v_mov_b32 v157, 0
  v_mov_b32 v158, 0
  v_mov_b32 v159, 0
  v_mov_b32 v160, 0
  v_mov_b32 v161, 0
  v_mov_b32 v162, 0
  v_mov_b32 v163, 0
  v_mov_b32 v164, 0
  v_mov_b32 v165, 0
  v_mov_b32 v166, 0
  v_mov_b32 v167, 0
  v_mov_b32 v168, 0
  v_mov_b32 v169, 0
  v_mov_b32 v170, 0
  v_mov_b32 v171, 0
  v_mov_b32 v172, 0
  v_mov_b32 v173, 0
  v_mov_b32 v174, 0
  v_mov_b32 v175, 0
  v_mov_b32 v176, 0
  v_mov_b32 v177, 0
  v_mov_b32 v178, 0
  v_mov_b32 v179, 0
  v_mov_b32 v180, 0
  v_mov_b32 v181, 0
  v_mov_b32 v182, 0
  v_mov_b32 v183, 0
  v_mov_b32 v184, 0
  v_mov_b32 v185, 0
  v_mov_b32 v186, 0
  v_mov_b32 v187, 0
  v_mov_b32 v188, 0
  v_mov_b32 v189, 0
  v_mov_b32 v190, 0
  v_mov_b32 v191, 0
  v_mov_b32 v192, 0
  v_mov_b32 v193, 0
  v_mov_b32 v194, 0
  v_mov_b32 v195, 0
  v_mov_b32 v196, 0
  v_mov_b32 v197, 0
  v_mov_b32 v198, 0
  v_mov_b32 v199, 0
  v_mov_b32 v216, 0
  v_mov_b32 v217, 0
  v_mov_b32 v218, 0
  v_mov_b32 v219, 0
  v_mov_b32 v220, 0
  v_mov_b32 v221, 0
  v_mov_b32 v222, 0
  v_mov_b32 v223, 0
  v_mov_b32 v224, 0
  v_mov_b32 v225, 0
  v_mov_b32 v226, 0
  v_mov_b32 v227, 0
  v_mov_b32 v248, 0x3f803f80
  v_mov_b32 v249, 0x3f803f80
  v_and_b32 v1, 15, v0
  v_bfe_u32 v2, v0, 4, 1
  v_cmp_eq_u32 vcc, v1, v2
  v_mov_b32 v3, 0x3f803f80
  s_nop 0
  v_cndmask_b32 v228, 0, v3, vcc
  v_mov_b32 v229, v228
  v_mov_b32 v230, v228
  v_mov_b32 v231, v228
  s_waitcnt lgkmcnt(0)
  s_mul_i32 s3, s3, 0x9E3779B1
  s_add_u32 s3, s3, 0x7F4A7C15
  s_barrier
  ds_read_b128 v[8:11], v240 offset:0
  ds_read_b64_tr_b16 v[200:201], v236 offset:16384
  ds_read_b64_tr_b16 v[202:203], v236 offset:17152
  ds_read_b64_tr_b16 v[204:205], v236 offset:16448
  ds_read_b64_tr_b16 v[206:207], v236 offset:17216
  ds_read_b64_tr_b16 v[208:209], v236 offset:16512
  ds_read_b64_tr_b16 v[210:211], v236 offset:17280
  s_waitcnt lgkmcnt(4)
  v_mfma_f32_32x32x16_bf16 v[136:151], v[200:203], v[8:11], v[136:151]
  ds_read_b128 v[12:15], v241 offset:0
  ds_read_b64_tr_b16 v[212:213], v237 offset:16384
  ds_read_b64_tr_b16 v[214:215], v237 offset:17152
  s_waitcnt lgkmcnt(5)
  v_mfma_f32_32x32x16_bf16 v[152:167], v[204:207], v[8:11], v[152:167]
  ds_read_b64_tr_b16 v[232:233], v237 offset:16448
  ds_read_b64_tr_b16 v[234:235], v237 offset:17216
  s_waitcnt lgkmcnt(5)
  v_mfma_f32_32x32x16_bf16 v[168:183], v[208:211], v[8:11], v[168:183]
  ds_read_b64_tr_b16 v[244:245], v237 offset:16512
  ds_read_b64_tr_b16 v[246:247], v237 offset:17280
  v_mfma_f32_16x16x32_bf16 v[216:219], v[228:231], v[200:203], v[216:219]
  s_waitcnt lgkmcnt(4)
  v_mfma_f32_32x32x16_bf16 v[136:151], v[212:215], v[12:15], v[136:151]
  ds_read_b128 v[16:19], v242 offset:0
  ds_read_b64_tr_b16 v[200:201], v238 offset:16384
  ds_read_b64_tr_b16 v[202:203], v238 offset:17152
  s_waitcnt lgkmcnt(5)
  v_mfma_f32_32x32x16_bf16 v[152:167], v[232:235], v[12:15], v[152:167]
  ds_read_b64_tr_b16 v[204:205], v238 offset:16448
  ds_read_b64_tr_b16 v[206:207], v238 offset:17216
  s_waitcnt lgkmcnt(5)
  v_mfma_f32_32x32x16_bf16 v[168:183], v[244:247], v[12:15], v[168:183]
  ds_read_b64_tr_b16 v[208:209], v238 offset:16512
  ds_read_b64_tr_b16 v[210:211], v238 offset:17280
  v_mfma_f32_16x16x32_bf16 v[220:223], v[228:231], v[232:235], v[220:223]
  s_waitcnt lgkmcnt(4)
  v_mfma_f32_32x32x16_bf16 v[136:151], v[200:203], v[16:19], v[136:151]
  ds_read_b128 v[20:23], v243 offset:0
  ds_read_b64_tr_b16 v[212:213], v239 offset:16384
  ds_read_b64_tr_b16 v[214:215], v239 offset:17152
  s_waitcnt lgkmcnt(5)
  v_mfma_f32_32x32x16_bf16 v[152:167], v[204:207], v[16:19], v[152:167]
  ds_read_b64_tr_b16 v[232:233], v239 offset:16448
  ds_read_b64_tr_b16 v[234:235], v239 offset:17216
  s_waitcnt lgkmcnt(5)
  v_mfma_f32_32x32x16_bf16 v[168:183], v[208:211], v[16:19], v[168:183]
  ds_read_b64_tr_b16 v[244:245], v239 offset:16512
  ds_read_b64_tr_b16 v[246:247], v239 offset:17280
  v_mfma_f32_16x16x32_bf16 v[224:227], v[228:231], v[208:211], v[224:227]
  s_barrier
  s_waitcnt lgkmcnt(4)
  v_mfma_f32_32x32x16_bf16 v[136:151], v[212:215], v[20:23], v[136:151]
  ds_read_b128 v[24:27], v240 offset:28672
  v_add_u32 v240, 57344, v240
  ds_read_b64_tr_b16 v[200:201], v236 offset:45056
  ds_read_b64_tr_b16 v[202:203], v236 offset:45824
  s_waitcnt lgkmcnt(5)
  v_mfma_f32_32x32x16_bf16 v[152:167], v[232:235], v[20:23], v[152:167]
  ds_read_b64_tr_b16 v[204:205], v236 offset:45120
  ds_read_b64_tr_b16 v[206:207], v236 offset:45888
  s_waitcnt lgkmcnt(5)
  v_mfma_f32_32x32x16_bf16 v[168:183], v[244:247], v[20:23], v[168:183]
  ds_read_b64_tr_b16 v[208:209], v236 offset:45184
  ds_read_b64_tr_b16 v[210:211], v236 offset:45952
  v_add_u32 v236, 57344, v236
  v_mfma_f32_4x4x4_16b_bf16 v[184:187], v[8:9], v[8:9], v[184:187]
  v_mfma_f32_4x4x4_16b_bf16 v[192:195], v[8:9], v[248:249], v[192:195]
  v_mfma_f32_4x4x4_16b_bf16 v[188:191], v[10:11], v[10:11], v[188:191]
  v_mfma_f32_4x4x4_16b_bf16 v[196:199], v[10:11], v[248:249], v[196:199]
  v_mfma_f32_4x4x4_16b_bf16 v[184:187], v[12:13], v[12:13], v[184:187]
  v_mfma_f32_4x4x4_16b_bf16 v[192:195], v[12:13], v[248:249], v[192:195]
  v_mfma_f32_4x4x4_16b_bf16 v[188:191], v[14:15], v[14:15], v[188:191]
  v_mfma_f32_4x4x4_16b_bf16 v[196:199], v[14:15], v[248:249], v[196:199]
  v_mfma_f32_4x4x4_16b_bf16 v[184:187], v[16:17], v[16:17], v[184:187]
  v_mfma_f32_4x4x4_16b_bf16 v[192:195], v[16:17], v[248:249], v[192:195]
  v_mfma_f32_4x4x4_16b_bf16 v[188:191], v[18:19], v[18:19], v[188:191]
  v_mfma_f32_4x4x4_16b_bf16 v[196:199], v[18:19], v[248:249], v[196:199]
  v_mfma_f32_4x4x4_16b_bf16 v[184:187], v[20:21], v[20:21], v[184:187]
  v_mfma_f32_4x4x4_16b_bf16 v[192:195], v[20:21], v[248:249], v[192:195]
  v_mfma_f32_4x4x4_16b_bf16 v[188:191], v[22:23], v[22:23], v[188:191]
  v_mfma_f32_4x4x4_16b_bf16 v[196:199], v[22:23], v[248:249], v[196:199]
  s_cmp_lg_u32 s25, 2
  s_cbranch_scc1 L_mpf_5
  s_mul_i32 s29, s2, 43
  v_add_u32 v1, s29, v0
  v_lshlrev_b32 v1, 7, v1
  s_mov_b32 s30, 0xffffffff
  s_mov_b32 s31, 0x7ff
  s_mov_b64 exec, s[30:31]
  buffer_load_dword v250, v1, s[16:19], 0 offen
  s_mov_b64 exec, -1
L_mpf_5:
  s_cmp_lg_u32 s25, 3
  s_cbranch_scc1 L_mpf_6
  s_mul_i32 s29, s2, 43
  v_add_u32 v1, s29, v0
  v_lshlrev_b32 v1, 7, v1
  s_mov_b32 s30, 0xffffffff
  s_mov_b32 s31, 0x7ff
  s_mov_b64 exec, s[30:31]
  buffer_load_dword v250, v1, s[4:7], 0 offen
  s_mov_b64 exec, -1
L_mpf_6:
  s_waitcnt lgkmcnt(4)
  v_mfma_f32_32x32x16_bf16 v[136:151], v[200:203], v[24:27], v[136:151]
  ds_read_b128 v[28:31], v241 offset:28672
  v_add_u32 v241, 57344, v241
  ds_read_b64_tr_b16 v[212:213], v237 offset:45056
  ds_read_b64_tr_b16 v[214:215], v237 offset:45824
  s_waitcnt lgkmcnt(5)
  v_mfma_f32_32x32x16_bf16 v[152:167], v[204:207], v[24:27], v[152:167]
  ds_read_b64_tr_b16 v[232:233], v237 offset:45120
  ds_read_b64_tr_b16 v[234:235], v237 offset:45888
  s_waitcnt lgkmcnt(5)
  v_mfma_f32_32x32x16_bf16 v[168:183], v[208:211], v[24:27], v[168:183]
  ds_read_b64_tr_b16 v[244:245], v237 offset:45184
  ds_read_b64_tr_b16 v[246:247], v237 offset:45952
  v_add_u32 v237, 57344, v237
  v_mfma_f32_16x16x32_bf16 v[216:219], v[228:231], v[200:203], v[216:219]
  s_waitcnt lgkmcnt(4)
  v_mfma_f32_32x32x16_bf16 v[136:151], v[212:215], v[28:31], v[136:151]
  ds_read_b128 v[32:35], v242 offset:28672
  v_add_u32 v242, 57344, v242
  ds_read_b64_tr_b16 v[200:201], v238 offset:45056
  ds_read_b64_tr_b16 v[202:203], v238 offset:45824
  s_waitcnt lgkmcnt(5)
  v_mfma_f32_32x32x16_bf16 v[152:167], v[232:235], v[28:31], v[152:167]
  ds_read_b64_tr_b16 v[204:205], v238 offset:45120
  ds_read_b64_tr_b16 v[206:207], v238 offset:45888
  s_waitcnt lgkmcnt(5)
  v_mfma_f32_32x32x16_bf16 v[168:183], v[244:247], v[28:31], v[168:183]
  ds_read_b64_tr_b16 v[208:209], v238 offset:45184
  ds_read_b64_tr_b16 v[210:211], v238 offset:45952
  v_add_u32 v238, 57344, v238
  v_mfma_f32_16x16x32_bf16 v[220:223], v[228:231], v[232:235], v[220:223]
  s_waitcnt lgkmcnt(4)
  v_mfma_f32_32x32x16_bf16 v[136:151], v[200:203], v[32:35], v[136:151]
  ds_read_b128 v[36:39], v243 offset:28672
  v_add_u32 v243, 57344, v243
  ds_read_b64_tr_b16 v[212:213], v239 offset:45056
  ds_read_b64_tr_b16 v[214:215], v239 offset:45824
  s_waitcnt lgkmcnt(5)
  v_mfma_f32_32x32x16_bf16 v[152:167], v[204:207], v[32:35], v[152:167]
  ds_read_b64_tr_b16 v[232:233], v239 offset:45120
  ds_read_b64_tr_b16 v[234:235], v239 offset:45888
  s_waitcnt lgkmcnt(5)
  v_mfma_f32_32x32x16_bf16 v[168:183], v[208:211], v[32:35], v[168:183]
  ds_read_b64_tr_b16 v[244:245], v239 offset:45184
  ds_read_b64_tr_b16 v[246:247], v239 offset:45952
  v_add_u32 v239, 57344, v239
  v_mfma_f32_16x16x32_bf16 v[224:227], v[228:231], v[208:211], v[224:227]
  s_barrier
  s_waitcnt lgkmcnt(4)
  v_mfma_f32_32x32x16_bf16 v[136:151], v[212:215], v[36:39], v[136:151]
  ds_read_b128 v[40:43], v240 offset:0
  ds_read_b64_tr_b16 v[200:201], v236 offset:16384
  ds_read_b64_tr_b16 v[202:203], v236 offset:17152
  s_waitcnt lgkmcnt(5)
  v_mfma_f32_32x32x16_bf16 v[152:167], v[232:235], v[36:39], v[152:167]
  ds_read_b64_tr_b16 v[204:205], v236 offset:16448
  ds_read_b64_tr_b16 v[206:207], v236 offset:17216
  s_waitcnt lgkmcnt(5)
  v_mfma_f32_32x32x16_bf16 v[168:183], v[244:247], v[36:39], v[168:183]
  ds_read_b64_tr_b16 v[208:209], v236 offset:16512
  ds_read_b64_tr_b16 v[210:211], v236 offset:17280
  v_mfma_f32_4x4x4_16b_bf16 v[184:187], v[24:25], v[24:25], v[184:187]
  v_mfma_f32_4x4x4_16b_bf16 v[192:195], v[24:25], v[248:249], v[192:195]
  v_mfma_f32_4x4x4_16b_bf16 v[188:191], v[26:27], v[26:27], v[188:191]
  v_mfma_f32_4x4x4_16b_bf16 v[196:199], v[26:27], v[248:249], v[196:199]
  v_mfma_f32_4x4x4_16b_bf16 v[184:187], v[28:29], v[28:29], v[184:187]
  v_mfma_f32_4x4x4_16b_bf16 v[192:195], v[28:29], v[248:249], v[192:195]
  v_mfma_f32_4x4x4_16b_bf16 v[188:191], v[30:31], v[30:31], v[188:191]
  v_mfma_f32_4x4x4_16b_bf16 v[196:199], v[30:31], v[248:249], v[196:199]
  v_mfma_f32_4x4x4_16b_bf16 v[184:187], v[32:33], v[32:33], v[184:187]
  v_mfma_f32_4x4x4_16b_bf16 v[192:195], v[32:33], v[248:249], v[192:195]
  v_mfma_f32_4x4x4_16b_bf16 v[188:191], v[34:35], v[34:35], v[188:191]
  v_mfma_f32_4x4x4_16b_bf16 v[196:199], v[34:35], v[248:249], v[196:199]
  v_mfma_f32_4x4x4_16b_bf16 v[184:187], v[36:37], v[36:37], v[184:187]
  v_mfma_f32_4x4x4_16b_bf16 v[192:195], v[36:37], v[248:249], v[192:195]
  v_mfma_f32_4x4x4_16b_bf16 v[188:191], v[38:39], v[38:39], v[188:191]
  v_mfma_f32_4x4x4_16b_bf16 v[196:199], v[38:39], v[248:249], v[196:199]
  s_waitcnt lgkmcnt(4)
  v_mfma_f32_32x32x16_bf16 v[136:151], v[200:203], v[40:43], v[136:151]
  ds_read_b128 v[44:47], v241 offset:0
  ds_read_b64_tr_b16 v[212:213], v237 offset:16384
  ds_read_b64_tr_b16 v[214:215], v237 offset:17152
  s_waitcnt lgkmcnt(5)
  v_mfma_f32_32x32x16_bf16 v[152:167], v[204:207], v[40:43], v[152:167]
  ds_read_b64_tr_b16 v[232:233], v237 offset:16448
  ds_read_b64_tr_b16 v[234:235], v237 offset:17216
  s_waitcnt lgkmcnt(5)
  v_mfma_f32_32x32x16_bf16 v[168:183], v[208:211], v[40:43], v[168:183]
  ds_read_b64_tr_b16 v[244:245], v237 offset:16512
  ds_read_b64_tr_b16 v[246:247], v237 offset:17280
  v_mfma_f32_16x16x32_bf16 v[216:219], v[228:231], v[200:203], v[216:219]
  s_waitcnt lgkmcnt(4)
  v_mfma_f32_32x32x16_bf16 v[136:151], v[212:215], v[44:47], v[136:151]
  ds_read_b128 v[48:51], v242 offset:0
  ds_read_b64_tr_b16 v[200:201], v238 offset:16384
  ds_read_b64_tr_b16 v[202:203], v238 offset:17152
  s_waitcnt lgkmcnt(5)
  v_mfma_f32_32x32x16_bf16 v[152:167], v[232:235], v[44:47], v[152:167]
  ds_read_b64_tr_b16 v[204:205], v238 offset:16448
  ds_read_b64_tr_b16 v[206:207], v238 offset:17216
  s_waitcnt lgkmcnt(5)
  v_mfma_f32_32x32x16_bf16 v[168:183], v[244:247], v[44:47], v[168:183]
  ds_read_b64_tr_b16 v[208:209], v238 offset:16512
  ds_read_b64_tr_b16 v[210:211], v238 offset:17280
  v_mfma_f32_16x16x32_bf16 v[220:223], v[228:231], v[232:235], v[220:223]
  s_waitcnt lgkmcnt(4)
  v_mfma_f32_32x32x16_bf16 v[136:151], v[200:203], v[48:51], v[136:151]
  ds_read_b128 v[52:55], v243 offset:0
  ds_read_b64_tr_b16 v[212:213], v239 offset:16384
  ds_read_b64_tr_b16 v[214:215], v239 offset:17152
  s_waitcnt lgkmcnt(5)
  v_mfma_f32_32x32x16_bf16 v[152:167], v[204:207], v[48:51], v[152:167]
  ds_read_b64_tr_b16 v[232:233], v239 offset:16448
  ds_read_b64_tr_b16 v[234:235], v239 offset:17216
  s_waitcnt lgkmcnt(5)
  v_mfma_f32_32x32x16_bf16 v[168:183], v[208:211], v[48:51], v[168:183]
  ds_read_b64_tr_b16 v[244:245], v239 offset:16512
  ds_read_b64_tr_b16 v[246:247], v239 offset:17280
  v_mfma_f32_16x16x32_bf16 v[224:227], v[228:231], v[208:211], v[224:227]
  s_barrier
  s_waitcnt lgkmcnt(4)
  v_mfma_f32_32x32x16_bf16 v[136:151], v[212:215], v[52:55], v[136:151]
  ds_read_b128 v[56:59], v240 offset:28672
  v_subrev_u32 v240, 57344, v240
  ds_read_b64_tr_b16 v[200:201], v236 offset:45056
  ds_read_b64_tr_b16 v[202:203], v236 offset:45824
  s_waitcnt lgkmcnt(5)
  v_mfma_f32_32x32x16_bf16 v[152:167], v[232:235], v[52:55], v[152:167]
  ds_read_b64_tr_b16 v[204:205], v236 offset:45120
  ds_read_b64_tr_b16 v[206:207], v236 offset:45888
  s_waitcnt lgkmcnt(5)
  v_mfma_f32_32x32x16_bf16 v[168:183], v[244:247], v[52:55], v[168:183]
  ds_read_b64_tr_b16 v[208:209], v236 offset:45184
  ds_read_b64_tr_b16 v[210:211], v236 offset:45952
  v_subrev_u32 v236, 57344, v236
  v_mfma_f32_4x4x4_16b_bf16 v[184:187], v[40:41], v[40:41], v[184:187]
  v_mfma_f32_4x4x4_16b_bf16 v[192:195], v[40:41], v[248:249], v[192:195]
  v_mfma_f32_4x4x4_16b_bf16 v[188:191], v[42:43], v[42:43], v[188:191]
  v_mfma_f32_4x4x4_16b_bf16 v[196:199], v[42:43], v[248:249], v[196:199]
  v_mfma_f32_4x4x4_16b_bf16 v[184:187], v[44:45], v[44:45], v[184:187]
  v_mfma_f32_4x4x4_16b_bf16 v[192:195], v[44:45], v[248:249], v[192:195]
  v_mfma_f32_4x4x4_16b_bf16 v[188:191], v[46:47], v[46:47], v[188:191]
  v_mfma_f32_4x4x4_16b_bf16 v[196:199], v[46:47], v[248:249], v[196:199]
  v_mfma_f32_4x4x4_16b_bf16 v[184:187], v[48:49], v[48:49], v[184:187]
  v_mfma_f32_4x4x4_16b_bf16 v[192:195], v[48:49], v[248:249], v[192:195]
  v_mfma_f32_4x4x4_16b_bf16 v[188:191], v[50:51], v[50:51], v[188:191]
  v_mfma_f32_4x4x4_16b_bf16 v[196:199], v[50:51], v[248:249], v[196:199]
  v_mfma_f32_4x4x4_16b_bf16 v[184:187], v[52:53], v[52:53], v[184:187]
  v_mfma_f32_4x4x4_16b_bf16 v[192:195], v[52:53], v[248:249], v[192:195]
  v_mfma_f32_4x4x4_16b_bf16 v[188:191], v[54:55], v[54:55], v[188:191]
  v_mfma_f32_4x4x4_16b_bf16 v[196:199], v[54:55], v[248:249], v[196:199]
  s_waitcnt lgkmcnt(4)
  v_mfma_f32_32x32x16_bf16 v[136:151], v[200:203], v[56:59], v[136:151]
  ds_read_b128 v[60:63], v241 offset:28672
  v_subrev_u32 v241, 57344, v241
  ds_read_b64_tr_b16 v[212:213], v237 offset:45056
  ds_read_b64_tr_b16 v[214:215], v237 offset:45824
  s_waitcnt lgkmcnt(5)
  v_mfma_f32_32x32x16_bf16 v[152:167], v[204:207], v[56:59], v[152:167]
  ds_read_b64_tr_b16 v[232:233], v237 offset:45120
  ds_read_b64_tr_b16 v[234:235], v237 offset:45888
  s_waitcnt lgkmcnt(5)
  v_mfma_f32_32x32x16_bf16 v[168:183], v[208:211], v[56:59], v[168:183]
  ds_read_b64_tr_b16 v[244:245], v237 offset:45184
  ds_read_b64_tr_b16 v[246:247], v237 offset:45952
  v_subrev_u32 v237, 57344, v237
  v_mfma_f32_16x16x32_bf16 v[216:219], v[228:231], v[200:203], v[216:219]
  s_waitcnt lgkmcnt(4)
  v_mfma_f32_32x32x16_bf16 v[136:151], v[212:215], v[60:63], v[136:151]
  ds_read_b128 v[64:67], v242 offset:28672
  v_subrev_u32 v242, 57344, v242
  ds_read_b64_tr_b16 v[200:201], v238 offset:45056
  ds_read_b64_tr_b16 v[202:203], v238 offset:45824
  s_waitcnt lgkmcnt(5)
  v_mfma_f32_32x32x16_bf16 v[152:167], v[232:235], v[60:63], v[152:167]
  ds_read_b64_tr_b16 v[204:205], v238 offset:45120
  ds_read_b64_tr_b16 v[206:207], v238 offset:45888
  s_waitcnt lgkmcnt(5)
  v_mfma_f32_32x32x16_bf16 v[168:183], v[244:247], v[60:63], v[168:183]
  ds_read_b64_tr_b16 v[208:209], v238 offset:45184
  ds_read_b64_tr_b16 v[210:211], v238 offset:45952
  v_subrev_u32 v238, 57344, v238
  v_mfma_f32_16x16x32_bf16 v[220:223], v[228:231], v[232:235], v[220:223]
  s_waitcnt lgkmcnt(4)
  v_mfma_f32_32x32x16_bf16 v[136:151], v[200:203], v[64:67], v[136:151]
  ds_read_b128 v[68:71], v243 offset:28672
  v_subrev_u32 v243, 57344, v243
  ds_read_b64_tr_b16 v[212:213], v239 offset:45056
  ds_read_b64_tr_b16 v[214:215], v239 offset:45824
  s_waitcnt lgkmcnt(5)
  v_mfma_f32_32x32x16_bf16 v[152:167], v[204:207], v[64:67], v[152:167]
  ds_read_b64_tr_b16 v[232:233], v239 offset:45120
  ds_read_b64_tr_b16 v[234:235], v239 offset:45888
  s_waitcnt lgkmcnt(5)
  v_mfma_f32_32x32x16_bf16 v[168:183], v[208:211], v[64:67], v[168:183]
  ds_read_b64_tr_b16 v[244:245], v239 offset:45184
  ds_read_b64_tr_b16 v[246:247], v239 offset:45952
  v_subrev_u32 v239, 57344, v239
  v_mfma_f32_16x16x32_bf16 v[224:227], v[228:231], v[208:211], v[224:227]
  s_barrier
  s_waitcnt lgkmcnt(4)
  v_mfma_f32_32x32x16_bf16 v[136:151], v[212:215], v[68:71], v[136:151]
  ds_read_b128 v[72:75], v240 offset:0
  ds_read_b64_tr_b16 v[200:201], v236 offset:16384
  ds_read_b64_tr_b16 v[202:203], v236 offset:17152
  s_waitcnt lgkmcnt(5)
  v_mfma_f32_32x32x16_bf16 v[152:167], v[232:235], v[68:71], v[152:167]
  ds_read_b64_tr_b16 v[204:205], v236 offset:16448
  ds_read_b64_tr_b16 v[206:207], v236 offset:17216
  s_waitcnt lgkmcnt(5)
  v_mfma_f32_32x32x16_bf16 v[168:183], v[244:247], v[68:71], v[168:183]
  ds_read_b64_tr_b16 v[208:209], v236 offset:16512
  ds_read_b64_tr_b16 v[210:211], v236 offset:17280
  v_mfma_f32_4x4x4_16b_bf16 v[184:187], v[56:57], v[56:57], v[184:187]
  v_mfma_f32_4x4x4_16b_bf16 v[192:195], v[56:57], v[248:249], v[192:195]
  v_mfma_f32_4x4x4_16b_bf16 v[188:191], v[58:59], v[58:59], v[188:191]
  v_mfma_f32_4x4x4_16b_bf16 v[196:199], v[58:59], v[248:249], v[196:199]
  v_mfma_f32_4x4x4_16b_bf16 v[184:187], v[60:61], v[60:61], v[184:187]
  v_mfma_f32_4x4x4_16b_bf16 v[192:195], v[60:61], v[248:249], v[192:195]
  v_mfma_f32_4x4x4_16b_bf16 v[188:191], v[62:63], v[62:63], v[188:191]
  v_mfma_f32_4x4x4_16b_bf16 v[196:199], v[62:63], v[248:249], v[196:199]
  v_mfma_f32_4x4x4_16b_bf16 v[184:187], v[64:65], v[64:65], v[184:187]
  v_mfma_f32_4x4x4_16b_bf16 v[192:195], v[64:65], v[248:249], v[192:195]
  v_mfma_f32_4x4x4_16b_bf16 v[188:191], v[66:67], v[66:67], v[188:191]
  v_mfma_f32_4x4x4_16b_bf16 v[196:199], v[66:67], v[248:249], v[196:199]
  v_mfma_f32_4x4x4_16b_bf16 v[184:187], v[68:69], v[68:69], v[184:187]
  v_mfma_f32_4x4x4_16b_bf16 v[192:195], v[68:69], v[248:249], v[192:195]
  v_mfma_f32_4x4x4_16b_bf16 v[188:191], v[70:71], v[70:71], v[188:191]
  v_mfma_f32_4x4x4_16b_bf16 v[196:199], v[70:71], v[248:249], v[196:199]
  s_waitcnt lgkmcnt(4)
  v_mfma_f32_32x32x16_bf16 v[136:151], v[200:203], v[72:75], v[136:151]
  ds_read_b128 v[76:79], v241 offset:0
  ds_read_b64_tr_b16 v[212:213], v237 offset:16384
  ds_read_b64_tr_b16 v[214:215], v237 offset:17152
  s_waitcnt lgkmcnt(5)
  v_mfma_f32_32x32x16_bf16 v[152:167], v[204:207], v[72:75], v[152:167]
  ds_read_b64_tr_b16 v[232:233], v237 offset:16448
  ds_read_b64_tr_b16 v[234:235], v237 offset:17216
  s_waitcnt lgkmcnt(5)
  v_mfma_f32_32x32x16_bf16 v[168:183], v[208:211], v[72:75], v[168:183]
  ds_read_b64_tr_b16 v[244:245], v237 offset:16512
  ds_read_b64_tr_b16 v[246:247], v237 offset:17280
  v_mfma_f32_16x16x32_bf16 v[216:219], v[228:231], v[200:203], v[216:219]
  s_waitcnt lgkmcnt(4)
  v_mfma_f32_32x32x16_bf16 v[136:151], v[212:215], v[76:79], v[136:151]
  ds_read_b128 v[80:83], v242 offset:0
  ds_read_b64_tr_b16 v[200:201], v238 offset:16384
  ds_read_b64_tr_b16 v[202:203], v238 offset:17152
  s_waitcnt lgkmcnt(5)
  v_mfma_f32_32x32x16_bf16 v[152:167], v[232:235], v[76:79], v[152:167]
  ds_read_b64_tr_b16 v[204:205], v238 offset:16448
  ds_read_b64_tr_b16 v[206:207], v238 offset:17216
  s_waitcnt lgkmcnt(5)
  v_mfma_f32_32x32x16_bf16 v[168:183], v[244:247], v[76:79], v[168:183]
  ds_read_b64_tr_b16 v[208:209], v238 offset:16512
  ds_read_b64_tr_b16 v[210:211], v238 offset:17280
  v_mfma_f32_16x16x32_bf16 v[220:223], v[228:231], v[232:235], v[220:223]
  s_waitcnt lgkmcnt(4)
  v_mfma_f32_32x32x16_bf16 v[136:151], v[200:203], v[80:83], v[136:151]
  ds_read_b128 v[84:87], v243 offset:0
  ds_read_b64_tr_b16 v[212:213], v239 offset:16384
  ds_read_b64_tr_b16 v[214:215], v239 offset:17152
  s_waitcnt lgkmcnt(5)
  v_mfma_f32_32x32x16_bf16 v[152:167], v[204:207], v[80:83], v[152:167]
  ds_read_b64_tr_b16 v[232:233], v239 offset:16448
  ds_read_b64_tr_b16 v[234:235], v239 offset:17216
  s_waitcnt lgkmcnt(5)
  v_mfma_f32_32x32x16_bf16 v[168:183], v[208:211], v[80:83], v[168:183]
  ds_read_b64_tr_b16 v[244:245], v239 offset:16512
  ds_read_b64_tr_b16 v[246:247], v239 offset:17280
  v_mfma_f32_16x16x32_bf16 v[224:227], v[228:231], v[208:211], v[224:227]
  s_barrier
  s_waitcnt lgkmcnt(4)
  v_mfma_f32_32x32x16_bf16 v[136:151], v[212:215], v[84:87], v[136:151]
  ds_read_b128 v[88:91], v240 offset:28672
  v_add_u32 v240, 57344, v240
  ds_read_b64_tr_b16 v[200:201], v236 offset:45056
  ds_read_b64_tr_b16 v[202:203], v236 offset:45824
  s_waitcnt lgkmcnt(5)
  v_mfma_f32_32x32x16_bf16 v[152:167], v[232:235], v[84:87], v[152:167]
  ds_read_b64_tr_b16 v[204:205], v236 offset:45120
  ds_read_b64_tr_b16 v[206:207], v236 offset:45888
  s_waitcnt lgkmcnt(5)
  v_mfma_f32_32x32x16_bf16 v[168:183], v[244:247], v[84:87], v[168:183]
  ds_read_b64_tr_b16 v[208:209], v236 offset:45184
  ds_read_b64_tr_b16 v[210:211], v236 offset:45952
  v_add_u32 v236, 57344, v236
  v_mfma_f32_4x4x4_16b_bf16 v[184:187], v[72:73], v[72:73], v[184:187]
  v_mfma_f32_4x4x4_16b_bf16 v[192:195], v[72:73], v[248:249], v[192:195]
  v_mfma_f32_4x4x4_16b_bf16 v[188:191], v[74:75], v[74:75], v[188:191]
  v_mfma_f32_4x4x4_16b_bf16 v[196:199], v[74:75], v[248:249], v[196:199]
  v_mfma_f32_4x4x4_16b_bf16 v[184:187], v[76:77], v[76:77], v[184:187]
  v_mfma_f32_4x4x4_16b_bf16 v[192:195], v[76:77], v[248:249], v[192:195]
  v_mfma_f32_4x4x4_16b_bf16 v[188:191], v[78:79], v[78:79], v[188:191]
  v_mfma_f32_4x4x4_16b_bf16 v[196:199], v[78:79], v[248:249], v[196:199]
  v_mfma_f32_4x4x4_16b_bf16 v[184:187], v[80:81], v[80:81], v[184:187]
  v_mfma_f32_4x4x4_16b_bf16 v[192:195], v[80:81], v[248:249], v[192:195]
  v_mfma_f32_4x4x4_16b_bf16 v[188:191], v[82:83], v[82:83], v[188:191]
  v_mfma_f32_4x4x4_16b_bf16 v[196:199], v[82:83], v[248:249], v[196:199]
  v_mfma_f32_4x4x4_16b_bf16 v[184:187], v[84:85], v[84:85], v[184:187]
  v_mfma_f32_4x4x4_16b_bf16 v[192:195], v[84:85], v[248:249], v[192:195]
  v_mfma_f32_4x4x4_16b_bf16 v[188:191], v[86:87], v[86:87], v[188:191]
  v_mfma_f32_4x4x4_16b_bf16 v[196:199], v[86:87], v[248:249], v[196:199]
  s_waitcnt lgkmcnt(4)
  v_mfma_f32_32x32x16_bf16 v[136:151], v[200:203], v[88:91], v[136:151]
  ds_read_b128 v[92:95], v241 offset:28672
  v_add_u32 v241, 57344, v241
  ds_read_b64_tr_b16 v[212:213], v237 offset:45056
  ds_read_b64_tr_b16 v[214:215], v237 offset:45824
  s_waitcnt lgkmcnt(5)
  v_mfma_f32_32x32x16_bf16 v[152:167], v[204:207], v[88:91], v[152:167]
  ds_read_b64_tr_b16 v[232:233], v237 offset:45120
  ds_read_b64_tr_b16 v[234:235], v237 offset:45888
  s_waitcnt lgkmcnt(5)
  v_mfma_f32_32x32x16_bf16 v[168:183], v[208:211], v[88:91], v[168:183]
  ds_read_b64_tr_b16 v[244:245], v237 offset:45184
  ds_read_b64_tr_b16 v[246:247], v237 offset:45952
  v_add_u32 v237, 57344, v237
  v_mfma_f32_16x16x32_bf16 v[216:219], v[228:231], v[200:203], v[216:219]
  s_waitcnt lgkmcnt(4)
  v_mfma_f32_32x32x16_bf16 v[136:151], v[212:215], v[92:95], v[136:151]
  ds_read_b128 v[96:99], v242 offset:28672
  v_add_u32 v242, 57344, v242
  ds_read_b64_tr_b16 v[200:201], v238 offset:45056
  ds_read_b64_tr_b16 v[202:203], v238 offset:45824
  s_waitcnt lgkmcnt(5)
  v_mfma_f32_32x32x16_bf16 v[152:167], v[232:235], v[92:95], v[152:167]
  ds_read_b64_tr_b16 v[204:205], v238 offset:45120
  ds_read_b64_tr_b16 v[206:207], v238 offset:45888
  s_waitcnt lgkmcnt(5)
  v_mfma_f32_32x32x16_bf16 v[168:183], v[244:247], v[92:95], v[168:183]
  ds_read_b64_tr_b16 v[208:209], v238 offset:45184
  ds_read_b64_tr_b16 v[210:211], v238 offset:45952
  v_add_u32 v238, 57344, v238
  v_mfma_f32_16x16x32_bf16 v[220:223], v[228:231], v[232:235], v[220:223]
  s_waitcnt lgkmcnt(4)
  v_mfma_f32_32x32x16_bf16 v[136:151], v[200:203], v[96:99], v[136:151]
  ds_read_b128 v[100:103], v243 offset:28672
  v_add_u32 v243, 57344, v243
  ds_read_b64_tr_b16 v[212:213], v239 offset:45056
  ds_read_b64_tr_b16 v[214:215], v239 offset:45824
  s_waitcnt lgkmcnt(5)
  v_mfma_f32_32x32x16_bf16 v[152:167], v[204:207], v[96:99], v[152:167]
  ds_read_b64_tr_b16 v[232:233], v239 offset:45120
  ds_read_b64_tr_b16 v[234:235], v239 offset:45888
  s_waitcnt lgkmcnt(5)
  v_mfma_f32_32x32x16_bf16 v[168:183], v[208:211], v[96:99], v[168:183]
  ds_read_b64_tr_b16 v[244:245], v239 offset:45184
  ds_read_b64_tr_b16 v[246:247], v239 offset:45952
  v_add_u32 v239, 57344, v239
  v_mfma_f32_16x16x32_bf16 v[224:227], v[228:231], v[208:211], v[224:227]
  s_barrier
  s_waitcnt lgkmcnt(4)
  v_mfma_f32_32x32x16_bf16 v[136:151], v[212:215], v[100:103], v[136:151]
  ds_read_b128 v[104:107], v240 offset:0
  ds_read_b64_tr_b16 v[200:201], v236 offset:16384
  ds_read_b64_tr_b16 v[202:203], v236 offset:17152
  s_waitcnt lgkmcnt(5)
  v_mfma_f32_32x32x16_bf16 v[152:167], v[232:235], v[100:103], v[152:167]
  ds_read_b64_tr_b16 v[204:205], v236 offset:16448
  ds_read_b64_tr_b16 v[206:207], v236 offset:17216
  s_waitcnt lgkmcnt(5)
  v_mfma_f32_32x32x16_bf16 v[168:183], v[244:247], v[100:103], v[168:183]
  ds_read_b64_tr_b16 v[208:209], v236 offset:16512
  ds_read_b64_tr_b16 v[210:211], v236 offset:17280
  v_mfma_f32_4x4x4_16b_bf16 v[184:187], v[88:89], v[88:89], v[184:187]
  v_mfma_f32_4x4x4_16b_bf16 v[192:195], v[88:89], v[248:249], v[192:195]
  v_mfma_f32_4x4x4_16b_bf16 v[188:191], v[90:91], v[90:91], v[188:191]
  v_mfma_f32_4x4x4_16b_bf16 v[196:199], v[90:91], v[248:249], v[196:199]
  v_mfma_f32_4x4x4_16b_bf16 v[184:187], v[92:93], v[92:93], v[184:187]
  v_mfma_f32_4x4x4_16b_bf16 v[192:195], v[92:93], v[248:249], v[192:195]
  v_mfma_f32_4x4x4_16b_bf16 v[188:191], v[94:95], v[94:95], v[188:191]
  v_mfma_f32_4x4x4_16b_bf16 v[196:199], v[94:95], v[248:249], v[196:199]
  v_mfma_f32_4x4x4_16b_bf16 v[184:187], v[96:97], v[96:97], v[184:187]
  v_mfma_f32_4x4x4_16b_bf16 v[192:195], v[96:97], v[248:249], v[192:195]
  v_mfma_f32_4x4x4_16b_bf16 v[188:191], v[98:99], v[98:99], v[188:191]
  v_mfma_f32_4x4x4_16b_bf16 v[196:199], v[98:99], v[248:249], v[196:199]
  v_mfma_f32_4x4x4_16b_bf16 v[184:187], v[100:101], v[100:101], v[184:187]
  v_mfma_f32_4x4x4_16b_bf16 v[192:195], v[100:101], v[248:249], v[192:195]
  v_mfma_f32_4x4x4_16b_bf16 v[188:191], v[102:103], v[102:103], v[188:191]
  v_mfma_f32_4x4x4_16b_bf16 v[196:199], v[102:103], v[248:249], v[196:199]
  s_waitcnt lgkmcnt(4)
  v_mfma_f32_32x32x16_bf16 v[136:151], v[200:203], v[104:107], v[136:151]
  ds_read_b128 v[108:111], v241 offset:0
  ds_read_b64_tr_b16 v[212:213], v237 offset:16384
  ds_read_b64_tr_b16 v[214:215], v237 offset:17152
  s_waitcnt lgkmcnt(5)
  v_mfma_f32_32x32x16_bf16 v[152:167], v[204:207], v[104:107], v[152:167]
  ds_read_b64_tr_b16 v[232:233], v237 offset:16448
  ds_read_b64_tr_b16 v[234:235], v237 offset:17216
  s_waitcnt lgkmcnt(5)
  v_mfma_f32_32x32x16_bf16 v[168:183], v[208:211], v[104:107], v[168:183]
  ds_read_b64_tr_b16 v[244:245], v237 offset:16512
  ds_read_b64_tr_b16 v[246:247], v237 offset:17280
  v_mfma_f32_16x16x32_bf16 v[216:219], v[228:231], v[200:203], v[216:219]
  s_waitcnt lgkmcnt(4)
  v_mfma_f32_32x32x16_bf16 v[136:151], v[212:215], v[108:111], v[136:151]
  ds_read_b128 v[112:115], v242 offset:0
  ds_read_b64_tr_b16 v[200:201], v238 offset:16384
  ds_read_b64_tr_b16 v[202:203], v238 offset:17152
  s_waitcnt lgkmcnt(5)
  v_mfma_f32_32x32x16_bf16 v[152:167], v[232:235], v[108:111], v[152:167]
  ds_read_b64_tr_b16 v[204:205], v238 offset:16448
  ds_read_b64_tr_b16 v[206:207], v238 offset:17216
  s_waitcnt lgkmcnt(5)
  v_mfma_f32_32x32x16_bf16 v[168:183], v[244:247], v[108:111], v[168:183]
  ds_read_b64_tr_b16 v[208:209], v238 offset:16512
  ds_read_b64_tr_b16 v[210:211], v238 offset:17280
  v_mfma_f32_16x16x32_bf16 v[220:223], v[228:231], v[232:235], v[220:223]
  s_waitcnt lgkmcnt(4)
  v_mfma_f32_32x32x16_bf16 v[136:151], v[200:203], v[112:115], v[136:151]
  ds_read_b128 v[116:119], v243 offset:0
  ds_read_b64_tr_b16 v[212:213], v239 offset:16384
  ds_read_b64_tr_b16 v[214:215], v239 offset:17152
  s_waitcnt lgkmcnt(5)
  v_mfma_f32_32x32x16_bf16 v[152:167], v[204:207], v[112:115], v[152:167]
  ds_read_b64_tr_b16 v[232:233], v239 offset:16448
  ds_read_b64_tr_b16 v[234:235], v239 offset:17216
  s_waitcnt lgkmcnt(5)
  v_mfma_f32_32x32x16_bf16 v[168:183], v[208:211], v[112:115], v[168:183]
  ds_read_b64_tr_b16 v[244:245], v239 offset:16512
  ds_read_b64_tr_b16 v[246:247], v239 offset:17280
  v_mfma_f32_16x16x32_bf16 v[224:227], v[228:231], v[208:211], v[224:227]
  s_barrier
  s_waitcnt lgkmcnt(4)
  v_mfma_f32_32x32x16_bf16 v[136:151], v[212:215], v[116:119], v[136:151]
  ds_read_b128 v[120:123], v240 offset:28672
  v_subrev_u32 v240, 57344, v240
  ds_read_b64_tr_b16 v[200:201], v236 offset:45056
  ds_read_b64_tr_b16 v[202:203], v236 offset:45824
  s_waitcnt lgkmcnt(5)
  v_mfma_f32_32x32x16_bf16 v[152:167], v[232:235], v[116:119], v[152:167]
  ds_read_b64_tr_b16 v[204:205], v236 offset:45120
  ds_read_b64_tr_b16 v[206:207], v236 offset:45888
  s_waitcnt lgkmcnt(5)
  v_mfma_f32_32x32x16_bf16 v[168:183], v[244:247], v[116:119], v[168:183]
  ds_read_b64_tr_b16 v[208:209], v236 offset:45184
  ds_read_b64_tr_b16 v[210:211], v236 offset:45952
  v_subrev_u32 v236, 57344, v236
  v_mfma_f32_4x4x4_16b_bf16 v[184:187], v[104:105], v[104:105], v[184:187]
  v_mfma_f32_4x4x4_16b_bf16 v[192:195], v[104:105], v[248:249], v[192:195]
  v_mfma_f32_4x4x4_16b_bf16 v[188:191], v[106:107], v[106:107], v[188:191]
  v_mfma_f32_4x4x4_16b_bf16 v[196:199], v[106:107], v[248:249], v[196:199]
  v_mfma_f32_4x4x4_16b_bf16 v[184:187], v[108:109], v[108:109], v[184:187]
  v_mfma_f32_4x4x4_16b_bf16 v[192:195], v[108:109], v[248:249], v[192:195]
  v_mfma_f32_4x4x4_16b_bf16 v[188:191], v[110:111], v[110:111], v[188:191]
  v_mfma_f32_4x4x4_16b_bf16 v[196:199], v[110:111], v[248:249], v[196:199]
  v_mfma_f32_4x4x4_16b_bf16 v[184:187], v[112:113], v[112:113], v[184:187]
  v_mfma_f32_4x4x4_16b_bf16 v[192:195], v[112:113], v[248:249], v[192:195]
  v_mfma_f32_4x4x4_16b_bf16 v[188:191], v[114:115], v[114:115], v[188:191]
  v_mfma_f32_4x4x4_16b_bf16 v[196:199], v[114:115], v[248:249], v[196:199]
  v_mfma_f32_4x4x4_16b_bf16 v[184:187], v[116:117], v[116:117], v[184:187]
  v_mfma_f32_4x4x4_16b_bf16 v[192:195], v[116:117], v[248:249], v[192:195]
  v_mfma_f32_4x4x4_16b_bf16 v[188:191], v[118:119], v[118:119], v[188:191]
  v_mfma_f32_4x4x4_16b_bf16 v[196:199], v[118:119], v[248:249], v[196:199]
  s_waitcnt lgkmcnt(4)
  v_mfma_f32_32x32x16_bf16 v[136:151], v[200:203], v[120:123], v[136:151]
  ds_read_b128 v[124:127], v241 offset:28672
  v_subrev_u32 v241, 57344, v241
  ds_read_b64_tr_b16 v[212:213], v237 offset:45056
  ds_read_b64_tr_b16 v[214:215], v237 offset:45824
  s_waitcnt lgkmcnt(5)
  v_mfma_f32_32x32x16_bf16 v[152:167], v[204:207], v[120:123], v[152:167]
  ds_read_b64_tr_b16 v[232:233], v237 offset:45120
  ds_read_b64_tr_b16 v[234:235], v237 offset:45888
  s_waitcnt lgkmcnt(5)
  v_mfma_f32_32x32x16_bf16 v[168:183], v[208:211], v[120:123], v[168:183]
  ds_read_b64_tr_b16 v[244:245], v237 offset:45184
  ds_read_b64_tr_b16 v[246:247], v237 offset:45952
  v_subrev_u32 v237, 57344, v237
  v_mfma_f32_16x16x32_bf16 v[216:219], v[228:231], v[200:203], v[216:219]
  s_waitcnt lgkmcnt(4)
  v_mfma_f32_32x32x16_bf16 v[136:151], v[212:215], v[124:127], v[136:151]
  ds_read_b128 v[128:131], v242 offset:28672
  v_subrev_u32 v242, 57344, v242
  ds_read_b64_tr_b16 v[200:201], v238 offset:45056
  ds_read_b64_tr_b16 v[202:203], v238 offset:45824
  s_waitcnt lgkmcnt(5)
  v_mfma_f32_32x32x16_bf16 v[152:167], v[232:235], v[124:127], v[152:167]
  ds_read_b64_tr_b16 v[204:205], v238 offset:45120
  ds_read_b64_tr_b16 v[206:207], v238 offset:45888
  s_waitcnt lgkmcnt(5)
  v_mfma_f32_32x32x16_bf16 v[168:183], v[244:247], v[124:127], v[168:183]
  ds_read_b64_tr_b16 v[208:209], v238 offset:45184
  ds_read_b64_tr_b16 v[210:211], v238 offset:45952
  v_subrev_u32 v238, 57344, v238
  v_mfma_f32_16x16x32_bf16 v[220:223], v[228:231], v[232:235], v[220:223]
  s_waitcnt lgkmcnt(4)
  v_mfma_f32_32x32x16_bf16 v[136:151], v[200:203], v[128:131], v[136:151]
  ds_read_b128 v[132:135], v243 offset:28672
  v_subrev_u32 v243, 57344, v243
  ds_read_b64_tr_b16 v[212:213], v239 offset:45056
  ds_read_b64_tr_b16 v[214:215], v239 offset:45824
  s_waitcnt lgkmcnt(5)
  v_mfma_f32_32x32x16_bf16 v[152:167], v[204:207], v[128:131], v[152:167]
  ds_read_b64_tr_b16 v[232:233], v239 offset:45120
  ds_read_b64_tr_b16 v[234:235], v239 offset:45888
  s_waitcnt lgkmcnt(5)
  v_mfma_f32_32x32x16_bf16 v[168:183], v[208:211], v[128:131], v[168:183]
  ds_read_b64_tr_b16 v[244:245], v239 offset:45184
  ds_read_b64_tr_b16 v[246:247], v239 offset:45952
  v_subrev_u32 v239, 57344, v239
  v_mfma_f32_16x16x32_bf16 v[224:227], v[228:231], v[208:211], v[224:227]
  s_barrier
  s_waitcnt lgkmcnt(4)
  v_mfma_f32_32x32x16_bf16 v[136:151], v[212:215], v[132:135], v[136:151]
  s_waitcnt lgkmcnt(2)
  v_mfma_f32_32x32x16_bf16 v[152:167], v[232:235], v[132:135], v[152:167]
  s_waitcnt lgkmcnt(0)
  v_mfma_f32_32x32x16_bf16 v[168:183], v[244:247], v[132:135], v[168:183]
  v_mfma_f32_4x4x4_16b_bf16 v[184:187], v[120:121], v[120:121], v[184:187]
  v_mfma_f32_4x4x4_16b_bf16 v[192:195], v[120:121], v[248:249], v[192:195]
  v_mfma_f32_4x4x4_16b_bf16 v[188:191], v[122:123], v[122:123], v[188:191]
  v_mfma_f32_4x4x4_16b_bf16 v[196:199], v[122:123], v[248:249], v[196:199]
  v_mfma_f32_4x4x4_16b_bf16 v[184:187], v[124:125], v[124:125], v[184:187]
  v_mfma_f32_4x4x4_16b_bf16 v[192:195], v[124:125], v[248:249], v[192:195]
  v_mfma_f32_4x4x4_16b_bf16 v[188:191], v[126:127], v[126:127], v[188:191]
  v_mfma_f32_4x4x4_16b_bf16 v[196:199], v[126:127], v[248:249], v[196:199]
  v_mfma_f32_4x4x4_16b_bf16 v[184:187], v[128:129], v[128:129], v[184:187]
  v_mfma_f32_4x4x4_16b_bf16 v[192:195], v[128:129], v[248:249], v[192:195]
  v_mfma_f32_4x4x4_16b_bf16 v[188:191], v[130:131], v[130:131], v[188:191]
  v_mfma_f32_4x4x4_16b_bf16 v[196:199], v[130:131], v[248:249], v[196:199]
  v_mfma_f32_4x4x4_16b_bf16 v[184:187], v[132:133], v[132:133], v[184:187]
  v_mfma_f32_4x4x4_16b_bf16 v[192:195], v[132:133], v[248:249], v[192:195]
  v_mfma_f32_4x4x4_16b_bf16 v[188:191], v[134:135], v[134:135], v[188:191]
  v_mfma_f32_4x4x4_16b_bf16 v[196:199], v[134:135], v[248:249], v[196:199]
  s_nop 1
  v_lshlrev_b32 v1, 4, v0
  s_lshl_b32 s29, s25, 2
  s_add_u32 s29, s29, 132096
  v_add_u32 v1, s29, v1
  s_mov_b64 exec, 0xffff
  ds_write_b32 v1, v216 offset:0
  ds_write_b32 v1, v217 offset:256
  ds_write_b32 v1, v220 offset:512
  ds_write_b32 v1, v221 offset:768
  ds_write_b32 v1, v224 offset:1024
  ds_write_b32 v1, v225 offset:1280
  s_mov_b64 exec, -1
  s_nop 3
  v_add_f32 v184, v184, v188
  v_add_f32 v192, v192, v196
  v_add_f32 v185, v185, v189
  v_add_f32 v193, v193, v197
  v_add_f32 v186, v186, v190
  v_add_f32 v194, v194, v198
  v_add_f32 v187, v187, v191
  v_add_f32 v195, v195, v199
  v_and_b32 v1, 3, v0
  v_cmp_eq_u32 vcc, 1, v1
  v_cmp_eq_u32 s[30:31], 2, v1
  v_cmp_eq_u32 s[32:33], 3, v1
  s_nop 1
  v_cndmask_b32 v184, v184, v185, vcc
  v_cndmask_b32 v192, v192, v193, vcc
  v_cndmask_b32 v184, v184, v186, s[30:31]
  v_cndmask_b32 v192, v192, v194, s[30:31]
  v_cndmask_b32 v184, v184, v187, s[32:33]
  v_cndmask_b32 v192, v192, v195, s[32:33]
  v_and_b32 v1, 31, v0
  s_lshl_b32 s29, s25, 5
  v_mov_b32 v193, v192
  v_mov_b32 v185, v184
  v_add_u32 v1, s29, v1
  v_lshlrev_b32 v1, 3, v1
  v_permlane32_swap_b32 v192, v193
  v_permlane32_swap_b32 v184, v185
  v_add_u32 v1, 131072, v1
  s_nop 0
  v_add_f32 v192, v192, v193
  v_add_f32 v184, v184, v185
  v_mul_f32 v192, 0x3b000000, v192
  v_mul_f32 v184, 0x3b000000, v184
  v_fma_f32 v184, -v192, v192, v184
  v_max_f32 v184, 0, v184
  v_cvt_pk_bf16_f32 v200, v192, v192
  v_cvt_pk_bf16_f32 v201, v184, v184
  v_xor_b32 v200, 0x80008000, v200
  v_lshlrev_b32 v201, 16, v201
  v_add_f32 v201, 0x3727c5ac, v201
  v_cvt_pk_bf16_f32 v201, v201, v201
  v_lshlrev_b32 v201, 16, v201
  v_sqrt_f32 v201, v201
  v_cmp_gt_u32 vcc, 32, v0
  v_cvt_pk_bf16_f32 v201, v201, v201
  v_lshlrev_b32 v201, 16, v201
  s_mov_b32 exec_hi, 0
  ds_write_b64 v1, v[200:201]
  s_mov_b64 exec, -1
  v_mov_b32 v252, v201
  v_rcp_f32 v253, v201
  v_cndmask_b32 v251, 0, v200, vcc
  v_and_b32 v4, 31, v0
  v_lshlrev_b32 v4, 4, v4
  v_add_u32 v4, 132096, v4
  s_waitcnt lgkmcnt(0)
  s_barrier
  ds_read_b128 v[200:203], v4 offset:0
  ds_read_b128 v[204:207], v4 offset:512
  ds_read_b128 v[208:211], v4 offset:1024
  v_mov_b32 v213, 0
  v_mov_b32 v214, 0
  v_mov_b32 v215, 0
  v_mov_b32 v212, v251
  s_waitcnt lgkmcnt(2)
  v_add_f32 v200, v200, v201
  v_add_f32 v202, v202, v203
  v_mov_b32 v203, 0
  v_add_f32 v200, v200, v202
  v_cvt_pk_bf16_f32 v201, v200, v200
  v_lshlrev_b32 v201, 16, v201
  v_sub_f32 v202, v200, v201
  v_cvt_pk_bf16_f32 v200, v201, v202
  v_mov_b32 v201, 0
  v_mov_b32 v202, 0
  s_nop 1
  v_mfma_f32_32x32x16_bf16 v[136:151], v[200:203], v[212:215], v[136:151]
  s_waitcnt lgkmcnt(1)
  v_add_f32 v204, v204, v205
  v_add_f32 v206, v206, v207
  v_mov_b32 v207, 0
  v_add_f32 v204, v204, v206
  v_cvt_pk_bf16_f32 v205, v204, v204
  v_lshlrev_b32 v205, 16, v205
  v_sub_f32 v206, v204, v205
  v_cvt_pk_bf16_f32 v204, v205, v206
  v_mov_b32 v205, 0
  v_mov_b32 v206, 0
  s_nop 1
  v_mfma_f32_32x32x16_bf16 v[152:167], v[204:207], v[212:215], v[152:167]
  s_waitcnt lgkmcnt(0)
  v_add_f32 v208, v208, v209
  v_add_f32 v210, v210, v211
  v_mov_b32 v211, 0
  v_add_f32 v208, v208, v210
  v_cvt_pk_bf16_f32 v209, v208, v208
  v_lshlrev_b32 v209, 16, v209
  v_sub_f32 v210, v208, v209
  v_cvt_pk_bf16_f32 v208, v209, v210
  v_mov_b32 v209, 0
  v_mov_b32 v210, 0
  s_nop 1
  v_mfma_f32_32x32x16_bf16 v[168:183], v[208:211], v[212:215], v[168:183]
  s_nop 5
  s_cmp_lt_u32 s27, 10
  s_cbranch_scc1 L_u0_nva
  s_mul_i32 s33, s25, 6144
  s_add_u32 s33, s33, 135168
  v_and_b32 v1, 31, v0
  v_lshlrev_b32 v1, 6, v1
  v_lshrrev_b32 v2, 5, v0
  v_lshl_add_u32 v1, v2, 3, v1
  v_bfe_u32 v7, v0, 1, 2
  v_lshl_add_u32 v1, v7, 4, v1
  v_add_u32 v1, s33, v1
  v_lshlrev_b32 v5, 3, v2
  v_bfe_u32 v3, v0, 2, 2
  v_add_u32 v5, v5, v3
  v_lshlrev_b32 v5, 6, v5
  v_bfe_u32 v3, v0, 4, 1
  v_lshl_add_u32 v5, v3, 5, v5
  v_and_b32 v7, 3, v0
  v_lshl_add_u32 v5, v7, 3, v5
  v_bfe_u32 v7, v0, 3, 1
  v_lshlrev_b32 v7, 4, v7
  v_xor_b32 v5, v7, v5
  v_lshlrev_b32 v3, 16, v3
  v_lshl_add_u32 v3, v2, 8, v3
  v_and_b32 v7, 15, v0
  v_lshl_add_u32 v3, v7, 4, v3
  v_add_u32 v2, s33, v5
  v_xor_b32 v4, 32, v5
  v_add_u32 v4, s33, v4
L_u0_nva:
  s_mul_i32 s31, s27, 3
  s_add_u32 s30, s31, 0
  s_cmp_lt_u32 s30, 16
  s_cselect_b32 s29, 1052289595, 1.0
  v_mul_f32 v6, s29, v253
  s_lshl_b32 s66, s30, 17
  s_lshl_b32 s32, s48, 10
  s_add_u32 s66, s66, s32
  v_mul_f32 v136, v136, v6
  v_mul_f32 v137, v137, v6
  v_mul_f32 v138, v138, v6
  v_mul_f32 v139, v139, v6
  v_mul_f32 v140, v140, v6
  v_mul_f32 v141, v141, v6
  v_mul_f32 v142, v142, v6
  v_mul_f32 v143, v143, v6
  v_mul_f32 v144, v144, v6
  v_mul_f32 v145, v145, v6
  v_mul_f32 v146, v146, v6
  v_mul_f32 v147, v147, v6
  v_mul_f32 v148, v148, v6
  v_mul_f32 v149, v149, v6
  v_mul_f32 v150, v150, v6
  v_mul_f32 v151, v151, v6
  v_cvt_pk_bf16_f32 v200, v136, v137
  v_cvt_pk_bf16_f32 v201, v138, v139
  v_cvt_pk_bf16_f32 v202, v140, v141
  v_cvt_pk_bf16_f32 v203, v142, v143
  v_cvt_pk_bf16_f32 v204, v144, v145
  v_cvt_pk_bf16_f32 v205, v146, v147
  v_cvt_pk_bf16_f32 v206, v148, v149
  v_cvt_pk_bf16_f32 v207, v150, v151
  s_cmp_ge_u32 s30, 32
  s_cbranch_scc1 L_u0_v0
  s_add_u32 s32, s66, 65536
  buffer_store_dwordx4 v[200:203], v255, s[20:23], s66 offen sc1
  buffer_store_dwordx4 v[204:207], v255, s[20:23], s32 offen sc1
  s_branch L_u0_d0
L_u0_v0:
  ds_write_b64 v1, v[200:201] offset:0
  v_xor_b32 v5, 16, v1
  ds_write_b64 v5, v[202:203] offset:0
  v_xor_b32 v5, 32, v1
  ds_write_b64 v5, v[204:205] offset:0
  v_xor_b32 v5, 48, v1
  ds_write_b64 v5, v[206:207] offset:0
L_u0_d0:
  s_add_u32 s30, s31, 1
  s_cmp_lt_u32 s30, 16
  s_cselect_b32 s29, 1052289595, 1.0
  v_mul_f32 v6, s29, v253
  s_lshl_b32 s69, s30, 17
  s_lshl_b32 s32, s48, 10
  s_add_u32 s69, s69, s32
  v_mul_f32 v152, v152, v6
  v_mul_f32 v153, v153, v6
  v_mul_f32 v154, v154, v6
  v_mul_f32 v155, v155, v6
  v_mul_f32 v156, v156, v6
  v_mul_f32 v157, v157, v6
  v_mul_f32 v158, v158, v6
  v_mul_f32 v159, v159, v6
  v_mul_f32 v160, v160, v6
  v_mul_f32 v161, v161, v6
  v_mul_f32 v162, v162, v6
  v_mul_f32 v163, v163, v6
  v_mul_f32 v164, v164, v6
  v_mul_f32 v165, v165, v6
  v_mul_f32 v166, v166, v6
  v_mul_f32 v167, v167, v6
  v_cvt_pk_bf16_f32 v208, v152, v153
  v_cvt_pk_bf16_f32 v209, v154, v155
  v_cvt_pk_bf16_f32 v210, v156, v157
  v_cvt_pk_bf16_f32 v211, v158, v159
  v_cvt_pk_bf16_f32 v212, v160, v161
  v_cvt_pk_bf16_f32 v213, v162, v163
  v_cvt_pk_bf16_f32 v214, v164, v165
  v_cvt_pk_bf16_f32 v215, v166, v167
  s_cmp_ge_u32 s30, 32
  s_cbranch_scc1 L_u0_v1
  s_add_u32 s32, s69, 65536
  buffer_store_dwordx4 v[208:211], v255, s[20:23], s69 offen sc1
  buffer_store_dwordx4 v[212:215], v255, s[20:23], s32 offen sc1
  s_branch L_u0_d1
L_u0_v1:
  ds_write_b64 v1, v[208:209] offset:2048
  v_xor_b32 v5, 16, v1
  ds_write_b64 v5, v[210:211] offset:2048
  v_xor_b32 v5, 32, v1
  ds_write_b64 v5, v[212:213] offset:2048
  v_xor_b32 v5, 48, v1
  ds_write_b64 v5, v[214:215] offset:2048
L_u0_d1:
  s_add_u32 s30, s31, 2
  s_cmp_lt_u32 s30, 16
  s_cselect_b32 s29, 1052289595, 1.0
  v_mul_f32 v6, s29, v253
  s_lshl_b32 s43, s30, 17
  s_lshl_b32 s32, s48, 10
  s_add_u32 s43, s43, s32
  s_nop 3
  v_mul_f32 v168, v168, v6
  v_mul_f32 v169, v169, v6
  v_mul_f32 v170, v170, v6
  v_mul_f32 v171, v171, v6
  v_mul_f32 v172, v172, v6
  v_mul_f32 v173, v173, v6
  v_mul_f32 v174, v174, v6
  v_mul_f32 v175, v175, v6
  v_mul_f32 v176, v176, v6
  v_mul_f32 v177, v177, v6
  v_mul_f32 v178, v178, v6
  v_mul_f32 v179, v179, v6
  v_mul_f32 v180, v180, v6
  v_mul_f32 v181, v181, v6
  v_mul_f32 v182, v182, v6
  v_mul_f32 v183, v183, v6
  v_cvt_pk_bf16_f32 v216, v168, v169
  v_cvt_pk_bf16_f32 v217, v170, v171
  v_cvt_pk_bf16_f32 v218, v172, v173
  v_cvt_pk_bf16_f32 v219, v174, v175
  v_cvt_pk_bf16_f32 v220, v176, v177
  v_cvt_pk_bf16_f32 v221, v178, v179
  v_cvt_pk_bf16_f32 v222, v180, v181
  v_cvt_pk_bf16_f32 v223, v182, v183
  s_cmp_ge_u32 s30, 32
  s_cbranch_scc1 L_u0_v2
  s_add_u32 s32, s43, 65536
  buffer_store_dwordx4 v[216:219], v255, s[20:23], s43 offen sc1
  buffer_store_dwordx4 v[220:223], v255, s[20:23], s32 offen sc1
  s_branch L_u0_d2
L_u0_v2:
  ds_write_b64 v1, v[216:217] offset:4096
  v_xor_b32 v5, 16, v1
  ds_write_b64 v5, v[218:219] offset:4096
  v_xor_b32 v5, 32, v1
  ds_write_b64 v5, v[220:221] offset:4096
  v_xor_b32 v5, 48, v1
  ds_write_b64 v5, v[222:223] offset:4096
L_u0_d2:
  s_cmp_lt_u32 s27, 10
  s_cbranch_scc1 L_u0_nov
  s_waitcnt lgkmcnt(0)
  s_cmp_eq_u32 s27, 10
  s_cbranch_scc1 L_u0_vr0
  ds_read_b64_tr_b16 v[200:201], v2 offset:0
  ds_read_b64_tr_b16 v[202:203], v4 offset:256
  ds_read_b64_tr_b16 v[204:205], v2 offset:1024
  ds_read_b64_tr_b16 v[206:207], v4 offset:1280
L_u0_vr0:
  s_cmp_eq_u32 s27, 10
  s_cbranch_scc1 L_u0_vr1
  ds_read_b64_tr_b16 v[208:209], v2 offset:2048
  ds_read_b64_tr_b16 v[210:211], v4 offset:2304
  ds_read_b64_tr_b16 v[212:213], v2 offset:3072
  ds_read_b64_tr_b16 v[214:215], v4 offset:3328
L_u0_vr1:
  ds_read_b64_tr_b16 v[216:217], v2 offset:4096
  ds_read_b64_tr_b16 v[218:219], v4 offset:4352
  ds_read_b64_tr_b16 v[220:221], v2 offset:5120
  ds_read_b64_tr_b16 v[222:223], v4 offset:5376
  s_waitcnt lgkmcnt(0)
  s_cmp_eq_u32 s27, 10
  s_cbranch_scc1 L_u0_vs0
  buffer_store_dwordx4 v[200:203], v3, s[20:23], s66 offen sc1
  buffer_store_dwordx4 v[204:207], v3, s[20:23], s66 offen offset:512 sc1
L_u0_vs0:
  s_cmp_eq_u32 s27, 10
  s_cbranch_scc1 L_u0_vs1
  buffer_store_dwordx4 v[208:211], v3, s[20:23], s69 offen sc1
  buffer_store_dwordx4 v[212:215], v3, s[20:23], s69 offen offset:512 sc1
L_u0_vs1:
  buffer_store_dwordx4 v[216:219], v3, s[20:23], s43 offen sc1
  buffer_store_dwordx4 v[220:223], v3, s[20:23], s43 offen offset:512 sc1
L_u0_nov:
  s_nop 1
  ds_read_b64_tr_b16 v[200:201], v236 offset:0
  ds_read_b64_tr_b16 v[202:203], v236 offset:768
  ds_read_b64_tr_b16 v[204:205], v236 offset:12288
  ds_read_b64_tr_b16 v[206:207], v236 offset:13056
  ds_read_b64_tr_b16 v[208:209], v236 offset:64
  ds_read_b64_tr_b16 v[210:211], v236 offset:832
  ds_read_b64_tr_b16 v[212:213], v236 offset:12352
  ds_read_b64_tr_b16 v[214:215], v236 offset:13120
  v_mov_b32 v136, 0
  v_mov_b32 v137, 0
  v_mov_b32 v138, 0
  v_mov_b32 v139, 0
  v_mov_b32 v140, 0
  v_mov_b32 v141, 0
  v_mov_b32 v142, 0
  v_mov_b32 v143, 0
  v_mov_b32 v144, 0
  v_mov_b32 v145, 0
  v_mov_b32 v146, 0
  v_mov_b32 v147, 0
  v_mov_b32 v148, 0
  v_mov_b32 v149, 0
  v_mov_b32 v150, 0
  v_mov_b32 v151, 0
  v_mov_b32 v152, 0
  v_mov_b32 v153, 0
  v_mov_b32 v154, 0
  v_mov_b32 v155, 0
  v_mov_b32 v156, 0
  v_mov_b32 v157, 0
  v_mov_b32 v158, 0
  v_mov_b32 v159, 0
  v_mov_b32 v160, 0
  v_mov_b32 v161, 0
  v_mov_b32 v162, 0
  v_mov_b32 v163, 0
  v_mov_b32 v164, 0
  v_mov_b32 v165, 0
  v_mov_b32 v166, 0
  v_mov_b32 v167, 0
  v_mov_b32 v168, 0
  v_mov_b32 v169, 0
  v_mov_b32 v170, 0
  v_mov_b32 v171, 0
  v_mov_b32 v172, 0
  v_mov_b32 v173, 0
  v_mov_b32 v174, 0
  v_mov_b32 v175, 0
  v_mov_b32 v176, 0
  v_mov_b32 v177, 0
  v_mov_b32 v178, 0
  v_mov_b32 v179, 0
  v_mov_b32 v180, 0
  v_mov_b32 v181, 0
  v_mov_b32 v182, 0
  v_mov_b32 v183, 0
  v_mov_b32 v184, 0
  v_mov_b32 v185, 0
  v_mov_b32 v186, 0
  v_mov_b32 v187, 0
  v_mov_b32 v188, 0
  v_mov_b32 v189, 0
  v_mov_b32 v190, 0
  v_mov_b32 v191, 0
  v_mov_b32 v192, 0
  v_mov_b32 v193, 0
  v_mov_b32 v194, 0
  v_mov_b32 v195, 0
  v_mov_b32 v196, 0
  v_mov_b32 v197, 0
  v_mov_b32 v198, 0
  v_mov_b32 v199, 0
  v_mov_b32 v216, 0
  v_mov_b32 v217, 0
  v_mov_b32 v218, 0
  v_mov_b32 v219, 0
  v_mov_b32 v220, 0
  v_mov_b32 v221, 0
  v_mov_b32 v222, 0
  v_mov_b32 v223, 0
  v_mov_b32 v224, 0
  v_mov_b32 v225, 0
  v_mov_b32 v226, 0
  v_mov_b32 v227, 0
  v_mov_b32 v232, v228
  v_mov_b32 v233, v229
  v_mov_b32 v234, v230
  v_mov_b32 v235, v231
  v_mov_b32 v228, 0
  v_mov_b32 v229, 0
  v_mov_b32 v230, 0
  v_mov_b32 v231, 0
  s_waitcnt lgkmcnt(6)
  v_mfma_f32_32x32x16_bf16 v[136:151], v[200:203], v[8:11], v[136:151]
  v_mfma_f32_16x16x32_bf16 v[216:219], v[232:235], v[200:203], v[216:219]
  ds_read_b64_tr_b16 v[200:201], v237 offset:0
  ds_read_b64_tr_b16 v[202:203], v237 offset:768
  s_waitcnt lgkmcnt(6)
  v_mfma_f32_32x32x16_bf16 v[152:167], v[204:207], v[8:11], v[152:167]
  ds_read_b64_tr_b16 v[204:205], v237 offset:12288
  ds_read_b64_tr_b16 v[206:207], v237 offset:13056
  s_waitcnt lgkmcnt(6)
  v_mfma_f32_32x32x16_bf16 v[168:183], v[208:211], v[8:11], v[168:183]
  ds_read_b64_tr_b16 v[208:209], v237 offset:64
  ds_read_b64_tr_b16 v[210:211], v237 offset:832
  s_waitcnt lgkmcnt(6)
  v_mfma_f32_32x32x16_bf16 v[184:199], v[212:215], v[8:11], v[184:199]
  ds_read_b64_tr_b16 v[212:213], v237 offset:12352
  ds_read_b64_tr_b16 v[214:215], v237 offset:13120
  s_waitcnt lgkmcnt(6)
  v_mfma_f32_32x32x16_bf16 v[136:151], v[200:203], v[12:15], v[136:151]
  ds_read_b64_tr_b16 v[200:201], v238 offset:0
  ds_read_b64_tr_b16 v[202:203], v238 offset:768
  s_waitcnt lgkmcnt(6)
  v_mfma_f32_32x32x16_bf16 v[152:167], v[204:207], v[12:15], v[152:167]
  v_mfma_f32_16x16x32_bf16 v[220:223], v[232:235], v[204:207], v[220:223]
  ds_read_b64_tr_b16 v[204:205], v238 offset:12288
  ds_read_b64_tr_b16 v[206:207], v238 offset:13056
  s_waitcnt lgkmcnt(6)
  v_mfma_f32_32x32x16_bf16 v[168:183], v[208:211], v[12:15], v[168:183]
  ds_read_b64_tr_b16 v[208:209], v238 offset:64
  ds_read_b64_tr_b16 v[210:211], v238 offset:832
  s_waitcnt lgkmcnt(6)
  v_mfma_f32_32x32x16_bf16 v[184:199], v[212:215], v[12:15], v[184:199]
  ds_read_b64_tr_b16 v[212:213], v238 offset:12352
  ds_read_b64_tr_b16 v[214:215], v238 offset:13120
  s_barrier
  s_waitcnt lgkmcnt(6)
  v_mfma_f32_32x32x16_bf16 v[136:151], v[200:203], v[16:19], v[136:151]
  ds_read_b64_tr_b16 v[200:201], v239 offset:0
  ds_read_b64_tr_b16 v[202:203], v239 offset:768
  s_waitcnt lgkmcnt(6)
  v_mfma_f32_32x32x16_bf16 v[152:167], v[204:207], v[16:19], v[152:167]
  ds_read_b64_tr_b16 v[204:205], v239 offset:12288
  ds_read_b64_tr_b16 v[206:207], v239 offset:13056
  s_waitcnt lgkmcnt(6)
  v_mfma_f32_32x32x16_bf16 v[168:183], v[208:211], v[16:19], v[168:183]
  v_mfma_f32_16x16x32_bf16 v[224:227], v[232:235], v[208:211], v[224:227]
  ds_read_b64_tr_b16 v[208:209], v239 offset:64
  ds_read_b64_tr_b16 v[210:211], v239 offset:832
  s_waitcnt lgkmcnt(6)
  v_mfma_f32_32x32x16_bf16 v[184:199], v[212:215], v[16:19], v[184:199]
  ds_read_b64_tr_b16 v[212:213], v239 offset:12352
  ds_read_b64_tr_b16 v[214:215], v239 offset:13120
  s_waitcnt lgkmcnt(6)
  v_mfma_f32_32x32x16_bf16 v[136:151], v[200:203], v[20:23], v[136:151]
  ds_read_b64_tr_b16 v[200:201], v236 offset:28672
  ds_read_b64_tr_b16 v[202:203], v236 offset:29440
  s_waitcnt lgkmcnt(6)
  v_mfma_f32_32x32x16_bf16 v[152:167], v[204:207], v[20:23], v[152:167]
  ds_read_b64_tr_b16 v[204:205], v236 offset:40960
  ds_read_b64_tr_b16 v[206:207], v236 offset:41728
  s_waitcnt lgkmcnt(6)
  v_mfma_f32_32x32x16_bf16 v[168:183], v[208:211], v[20:23], v[168:183]
  ds_read_b64_tr_b16 v[208:209], v236 offset:28736
  ds_read_b64_tr_b16 v[210:211], v236 offset:29504
  s_waitcnt lgkmcnt(6)
  v_mfma_f32_32x32x16_bf16 v[184:199], v[212:215], v[20:23], v[184:199]
  v_mfma_f32_16x16x32_bf16 v[228:231], v[232:235], v[212:215], v[228:231]
  ds_read_b64_tr_b16 v[212:213], v236 offset:41024
  ds_read_b64_tr_b16 v[214:215], v236 offset:41792
  v_add_u32 v236, 57344, v236
  s_waitcnt lgkmcnt(6)
  v_mfma_f32_32x32x16_bf16 v[136:151], v[200:203], v[24:27], v[136:151]
  v_mfma_f32_16x16x32_bf16 v[216:219], v[232:235], v[200:203], v[216:219]
  ds_read_b64_tr_b16 v[200:201], v237 offset:28672
  ds_read_b64_tr_b16 v[202:203], v237 offset:29440
  s_waitcnt lgkmcnt(6)
  v_mfma_f32_32x32x16_bf16 v[152:167], v[204:207], v[24:27], v[152:167]
  ds_read_b64_tr_b16 v[204:205], v237 offset:40960
  ds_read_b64_tr_b16 v[206:207], v237 offset:41728
  s_waitcnt lgkmcnt(6)
  v_mfma_f32_32x32x16_bf16 v[168:183], v[208:211], v[24:27], v[168:183]
  ds_read_b64_tr_b16 v[208:209], v237 offset:28736
  ds_read_b64_tr_b16 v[210:211], v237 offset:29504
  s_waitcnt lgkmcnt(6)
  v_mfma_f32_32x32x16_bf16 v[184:199], v[212:215], v[24:27], v[184:199]
  ds_read_b64_tr_b16 v[212:213], v237 offset:41024
  ds_read_b64_tr_b16 v[214:215], v237 offset:41792
  v_add_u32 v237, 57344, v237
  s_waitcnt lgkmcnt(6)
  v_mfma_f32_32x32x16_bf16 v[136:151], v[200:203], v[28:31], v[136:151]
  ds_read_b64_tr_b16 v[200:201], v238 offset:28672
  ds_read_b64_tr_b16 v[202:203], v238 offset:29440
  s_waitcnt lgkmcnt(6)
  v_mfma_f32_32x32x16_bf16 v[152:167], v[204:207], v[28:31], v[152:167]
  v_mfma_f32_16x16x32_bf16 v[220:223], v[232:235], v[204:207], v[220:223]
  ds_read_b64_tr_b16 v[204:205], v238 offset:40960
  ds_read_b64_tr_b16 v[206:207], v238 offset:41728
  s_waitcnt lgkmcnt(6)
  v_mfma_f32_32x32x16_bf16 v[168:183], v[208:211], v[28:31], v[168:183]
  ds_read_b64_tr_b16 v[208:209], v238 offset:28736
  ds_read_b64_tr_b16 v[210:211], v238 offset:29504
  s_waitcnt lgkmcnt(6)
  v_mfma_f32_32x32x16_bf16 v[184:199], v[212:215], v[28:31], v[184:199]
  ds_read_b64_tr_b16 v[212:213], v238 offset:41024
  ds_read_b64_tr_b16 v[214:215], v238 offset:41792
  v_add_u32 v238, 57344, v238
  s_barrier
  s_waitcnt lgkmcnt(6)
  v_mfma_f32_32x32x16_bf16 v[136:151], v[200:203], v[32:35], v[136:151]
  ds_read_b64_tr_b16 v[200:201], v239 offset:28672
  ds_read_b64_tr_b16 v[202:203], v239 offset:29440
  s_waitcnt lgkmcnt(6)
  v_mfma_f32_32x32x16_bf16 v[152:167], v[204:207], v[32:35], v[152:167]
  ds_read_b64_tr_b16 v[204:205], v239 offset:40960
  ds_read_b64_tr_b16 v[206:207], v239 offset:41728
  s_waitcnt lgkmcnt(6)
  v_mfma_f32_32x32x16_bf16 v[168:183], v[208:211], v[32:35], v[168:183]
  v_mfma_f32_16x16x32_bf16 v[224:227], v[232:235], v[208:211], v[224:227]
  ds_read_b64_tr_b16 v[208:209], v239 offset:28736
  ds_read_b64_tr_b16 v[210:211], v239 offset:29504
  s_waitcnt lgkmcnt(6)
  v_mfma_f32_32x32x16_bf16 v[184:199], v[212:215], v[32:35], v[184:199]
  ds_read_b64_tr_b16 v[212:213], v239 offset:41024
  ds_read_b64_tr_b16 v[214:215], v239 offset:41792
  v_add_u32 v239, 57344, v239
  s_waitcnt lgkmcnt(6)
  v_mfma_f32_32x32x16_bf16 v[136:151], v[200:203], v[36:39], v[136:151]
  ds_read_b64_tr_b16 v[200:201], v236 offset:0
  ds_read_b64_tr_b16 v[202:203], v236 offset:768
  s_waitcnt lgkmcnt(6)
  v_mfma_f32_32x32x16_bf16 v[152:167], v[204:207], v[36:39], v[152:167]
  ds_read_b64_tr_b16 v[204:205], v236 offset:12288
  ds_read_b64_tr_b16 v[206:207], v236 offset:13056
  s_waitcnt lgkmcnt(6)
  v_mfma_f32_32x32x16_bf16 v[168:183], v[208:211], v[36:39], v[168:183]
  ds_read_b64_tr_b16 v[208:209], v236 offset:64
  ds_read_b64_tr_b16 v[210:211], v236 offset:832
  s_waitcnt lgkmcnt(6)
  v_mfma_f32_32x32x16_bf16 v[184:199], v[212:215], v[36:39], v[184:199]
  v_mfma_f32_16x16x32_bf16 v[228:231], v[232:235], v[212:215], v[228:231]
  ds_read_b64_tr_b16 v[212:213], v236 offset:12352
  ds_read_b64_tr_b16 v[214:215], v236 offset:13120
  s_waitcnt lgkmcnt(6)
  v_mfma_f32_32x32x16_bf16 v[136:151], v[200:203], v[40:43], v[136:151]
  v_mfma_f32_16x16x32_bf16 v[216:219], v[232:235], v[200:203], v[216:219]
  ds_read_b64_tr_b16 v[200:201], v237 offset:0
  ds_read_b64_tr_b16 v[202:203], v237 offset:768
  s_waitcnt lgkmcnt(6)
  v_mfma_f32_32x32x16_bf16 v[152:167], v[204:207], v[40:43], v[152:167]
  ds_read_b64_tr_b16 v[204:205], v237 offset:12288
  ds_read_b64_tr_b16 v[206:207], v237 offset:13056
  s_waitcnt lgkmcnt(6)
  v_mfma_f32_32x32x16_bf16 v[168:183], v[208:211], v[40:43], v[168:183]
  ds_read_b64_tr_b16 v[208:209], v237 offset:64
  ds_read_b64_tr_b16 v[210:211], v237 offset:832
  s_waitcnt lgkmcnt(6)
  v_mfma_f32_32x32x16_bf16 v[184:199], v[212:215], v[40:43], v[184:199]
  ds_read_b64_tr_b16 v[212:213], v237 offset:12352
  ds_read_b64_tr_b16 v[214:215], v237 offset:13120
  s_waitcnt lgkmcnt(6)
  v_mfma_f32_32x32x16_bf16 v[136:151], v[200:203], v[44:47], v[136:151]
  ds_read_b64_tr_b16 v[200:201], v238 offset:0
  ds_read_b64_tr_b16 v[202:203], v238 offset:768
  s_waitcnt lgkmcnt(6)
  v_mfma_f32_32x32x16_bf16 v[152:167], v[204:207], v[44:47], v[152:167]
  v_mfma_f32_16x16x32_bf16 v[220:223], v[232:235], v[204:207], v[220:223]
  ds_read_b64_tr_b16 v[204:205], v238 offset:12288
  ds_read_b64_tr_b16 v[206:207], v238 offset:13056
  s_waitcnt lgkmcnt(6)
  v_mfma_f32_32x32x16_bf16 v[168:183], v[208:211], v[44:47], v[168:183]
  ds_read_b64_tr_b16 v[208:209], v238 offset:64
  ds_read_b64_tr_b16 v[210:211], v238 offset:832
  s_waitcnt lgkmcnt(6)
  v_mfma_f32_32x32x16_bf16 v[184:199], v[212:215], v[44:47], v[184:199]
  ds_read_b64_tr_b16 v[212:213], v238 offset:12352
  ds_read_b64_tr_b16 v[214:215], v238 offset:13120
  s_waitcnt vmcnt(0)
  s_barrier
  s_lshl_b32 s29, s27, 7
  s_lshl_b32 s30, s28, 2
  s_add_u32 s29, s29, s30
  s_add_u32 s29, s29, 14024704
  s_cmp_lg_u32 s24, 0
  s_cbranch_scc1 L_sig_7
  v_mov_b32 v5, s29
  v_mov_b32 v6, s3
  s_mov_b64 exec, 1
  global_store_dword v5, v6, s[20:21] sc1
  s_mov_b64 exec, -1
L_sig_7:
  s_waitcnt lgkmcnt(6)
  v_mfma_f32_32x32x16_bf16 v[136:151], v[200:203], v[48:51], v[136:151]
  ds_read_b64_tr_b16 v[200:201], v239 offset:0
  ds_read_b64_tr_b16 v[202:203], v239 offset:768
  s_waitcnt lgkmcnt(6)
  v_mfma_f32_32x32x16_bf16 v[152:167], v[204:207], v[48:51], v[152:167]
  ds_read_b64_tr_b16 v[204:205], v239 offset:12288
  ds_read_b64_tr_b16 v[206:207], v239 offset:13056
  s_waitcnt lgkmcnt(6)
  v_mfma_f32_32x32x16_bf16 v[168:183], v[208:211], v[48:51], v[168:183]
  v_mfma_f32_16x16x32_bf16 v[224:227], v[232:235], v[208:211], v[224:227]
  ds_read_b64_tr_b16 v[208:209], v239 offset:64
  ds_read_b64_tr_b16 v[210:211], v239 offset:832
  s_waitcnt lgkmcnt(6)
  v_mfma_f32_32x32x16_bf16 v[184:199], v[212:215], v[48:51], v[184:199]
  ds_read_b64_tr_b16 v[212:213], v239 offset:12352
  ds_read_b64_tr_b16 v[214:215], v239 offset:13120
  s_waitcnt lgkmcnt(6)
  v_mfma_f32_32x32x16_bf16 v[136:151], v[200:203], v[52:55], v[136:151]
  ds_read_b64_tr_b16 v[200:201], v236 offset:28672
  ds_read_b64_tr_b16 v[202:203], v236 offset:29440
  s_waitcnt lgkmcnt(6)
  v_mfma_f32_32x32x16_bf16 v[152:167], v[204:207], v[52:55], v[152:167]
  ds_read_b64_tr_b16 v[204:205], v236 offset:40960
  ds_read_b64_tr_b16 v[206:207], v236 offset:41728
  s_waitcnt lgkmcnt(6)
  v_mfma_f32_32x32x16_bf16 v[168:183], v[208:211], v[52:55], v[168:183]
  ds_read_b64_tr_b16 v[208:209], v236 offset:28736
  ds_read_b64_tr_b16 v[210:211], v236 offset:29504
  s_waitcnt lgkmcnt(6)
  v_mfma_f32_32x32x16_bf16 v[184:199], v[212:215], v[52:55], v[184:199]
  v_mfma_f32_16x16x32_bf16 v[228:231], v[232:235], v[212:215], v[228:231]
  ds_read_b64_tr_b16 v[212:213], v236 offset:41024
  ds_read_b64_tr_b16 v[214:215], v236 offset:41792
  v_subrev_u32 v236, 57344, v236
  s_waitcnt lgkmcnt(6)
  v_mfma_f32_32x32x16_bf16 v[136:151], v[200:203], v[56:59], v[136:151]
  v_mfma_f32_16x16x32_bf16 v[216:219], v[232:235], v[200:203], v[216:219]
  ds_read_b64_tr_b16 v[200:201], v237 offset:28672
  ds_read_b64_tr_b16 v[202:203], v237 offset:29440
  s_waitcnt lgkmcnt(6)
  v_mfma_f32_32x32x16_bf16 v[152:167], v[204:207], v[56:59], v[152:167]
  ds_read_b64_tr_b16 v[204:205], v237 offset:40960
  ds_read_b64_tr_b16 v[206:207], v237 offset:41728
  s_waitcnt lgkmcnt(6)
  v_mfma_f32_32x32x16_bf16 v[168:183], v[208:211], v[56:59], v[168:183]
  ds_read_b64_tr_b16 v[208:209], v237 offset:28736
  ds_read_b64_tr_b16 v[210:211], v237 offset:29504
  s_waitcnt lgkmcnt(6)
  v_mfma_f32_32x32x16_bf16 v[184:199], v[212:215], v[56:59], v[184:199]
  ds_read_b64_tr_b16 v[212:213], v237 offset:41024
  ds_read_b64_tr_b16 v[214:215], v237 offset:41792
  v_subrev_u32 v237, 57344, v237
  s_waitcnt lgkmcnt(6)
  v_mfma_f32_32x32x16_bf16 v[136:151], v[200:203], v[60:63], v[136:151]
  ds_read_b64_tr_b16 v[200:201], v238 offset:28672
  ds_read_b64_tr_b16 v[202:203], v238 offset:29440
  s_waitcnt lgkmcnt(6)
  v_mfma_f32_32x32x16_bf16 v[152:167], v[204:207], v[60:63], v[152:167]
  v_mfma_f32_16x16x32_bf16 v[220:223], v[232:235], v[204:207], v[220:223]
  ds_read_b64_tr_b16 v[204:205], v238 offset:40960
  ds_read_b64_tr_b16 v[206:207], v238 offset:41728
  s_waitcnt lgkmcnt(6)
  v_mfma_f32_32x32x16_bf16 v[168:183], v[208:211], v[60:63], v[168:183]
  ds_read_b64_tr_b16 v[208:209], v238 offset:28736
  ds_read_b64_tr_b16 v[210:211], v238 offset:29504
  s_waitcnt lgkmcnt(6)
  v_mfma_f32_32x32x16_bf16 v[184:199], v[212:215], v[60:63], v[184:199]
  ds_read_b64_tr_b16 v[212:213], v238 offset:41024
  ds_read_b64_tr_b16 v[214:215], v238 offset:41792
  v_subrev_u32 v238, 57344, v238
  s_barrier
  s_waitcnt lgkmcnt(6)
  v_mfma_f32_32x32x16_bf16 v[136:151], v[200:203], v[64:67], v[136:151]
  ds_read_b64_tr_b16 v[200:201], v239 offset:28672
  ds_read_b64_tr_b16 v[202:203], v239 offset:29440
  s_waitcnt lgkmcnt(6)
  v_mfma_f32_32x32x16_bf16 v[152:167], v[204:207], v[64:67], v[152:167]
  ds_read_b64_tr_b16 v[204:205], v239 offset:40960
  ds_read_b64_tr_b16 v[206:207], v239 offset:41728
  s_waitcnt lgkmcnt(6)
  v_mfma_f32_32x32x16_bf16 v[168:183], v[208:211], v[64:67], v[168:183]
  v_mfma_f32_16x16x32_bf16 v[224:227], v[232:235], v[208:211], v[224:227]
  ds_read_b64_tr_b16 v[208:209], v239 offset:28736
  ds_read_b64_tr_b16 v[210:211], v239 offset:29504
  s_waitcnt lgkmcnt(6)
  v_mfma_f32_32x32x16_bf16 v[184:199], v[212:215], v[64:67], v[184:199]
  ds_read_b64_tr_b16 v[212:213], v239 offset:41024
  ds_read_b64_tr_b16 v[214:215], v239 offset:41792
  v_subrev_u32 v239, 57344, v239
  s_waitcnt lgkmcnt(6)
  v_mfma_f32_32x32x16_bf16 v[136:151], v[200:203], v[68:71], v[136:151]
  ds_read_b64_tr_b16 v[200:201], v236 offset:0
  ds_read_b64_tr_b16 v[202:203], v236 offset:768
  s_waitcnt lgkmcnt(6)
  v_mfma_f32_32x32x16_bf16 v[152:167], v[204:207], v[68:71], v[152:167]
  ds_read_b64_tr_b16 v[204:205], v236 offset:12288
  ds_read_b64_tr_b16 v[206:207], v236 offset:13056
  s_waitcnt lgkmcnt(6)
  v_mfma_f32_32x32x16_bf16 v[168:183], v[208:211], v[68:71], v[168:183]
  ds_read_b64_tr_b16 v[208:209], v236 offset:64
  ds_read_b64_tr_b16 v[210:211], v236 offset:832
  s_waitcnt lgkmcnt(6)
  v_mfma_f32_32x32x16_bf16 v[184:199], v[212:215], v[68:71], v[184:199]
  v_mfma_f32_16x16x32_bf16 v[228:231], v[232:235], v[212:215], v[228:231]
  ds_read_b64_tr_b16 v[212:213], v236 offset:12352
  ds_read_b64_tr_b16 v[214:215], v236 offset:13120
  s_waitcnt lgkmcnt(6)
  v_mfma_f32_32x32x16_bf16 v[136:151], v[200:203], v[72:75], v[136:151]
  v_mfma_f32_16x16x32_bf16 v[216:219], v[232:235], v[200:203], v[216:219]
  ds_read_b64_tr_b16 v[200:201], v237 offset:0
  ds_read_b64_tr_b16 v[202:203], v237 offset:768
  s_waitcnt lgkmcnt(6)
  v_mfma_f32_32x32x16_bf16 v[152:167], v[204:207], v[72:75], v[152:167]
  ds_read_b64_tr_b16 v[204:205], v237 offset:12288
  ds_read_b64_tr_b16 v[206:207], v237 offset:13056
  s_waitcnt lgkmcnt(6)
  v_mfma_f32_32x32x16_bf16 v[168:183], v[208:211], v[72:75], v[168:183]
  ds_read_b64_tr_b16 v[208:209], v237 offset:64
  ds_read_b64_tr_b16 v[210:211], v237 offset:832
  s_waitcnt lgkmcnt(6)
  v_mfma_f32_32x32x16_bf16 v[184:199], v[212:215], v[72:75], v[184:199]
  ds_read_b64_tr_b16 v[212:213], v237 offset:12352
  ds_read_b64_tr_b16 v[214:215], v237 offset:13120
  s_waitcnt lgkmcnt(6)
  v_mfma_f32_32x32x16_bf16 v[136:151], v[200:203], v[76:79], v[136:151]
  ds_read_b64_tr_b16 v[200:201], v238 offset:0
  ds_read_b64_tr_b16 v[202:203], v238 offset:768
  s_waitcnt lgkmcnt(6)
  v_mfma_f32_32x32x16_bf16 v[152:167], v[204:207], v[76:79], v[152:167]
  v_mfma_f32_16x16x32_bf16 v[220:223], v[232:235], v[204:207], v[220:223]
  ds_read_b64_tr_b16 v[204:205], v238 offset:12288
  ds_read_b64_tr_b16 v[206:207], v238 offset:13056
  s_waitcnt lgkmcnt(6)
  v_mfma_f32_32x32x16_bf16 v[168:183], v[208:211], v[76:79], v[168:183]
  ds_read_b64_tr_b16 v[208:209], v238 offset:64
  ds_read_b64_tr_b16 v[210:211], v238 offset:832
  s_waitcnt lgkmcnt(6)
  v_mfma_f32_32x32x16_bf16 v[184:199], v[212:215], v[76:79], v[184:199]
  ds_read_b64_tr_b16 v[212:213], v238 offset:12352
  ds_read_b64_tr_b16 v[214:215], v238 offset:13120
  s_barrier
  s_lshr_b32 s29, s49, 1
  v_and_b32 v1, 48, v0
  v_min_u32 v1, 32, v1
  v_add_u32 v1, s29, v1
  v_mul_u32_u24 v1, 0x5556, v1
  v_lshrrev_b32 v1, 16, v1
  v_lshlrev_b32 v1, 7, v1
  v_and_b32 v7, 15, v0
  v_lshl_add_u32 v7, v7, 2, v1
  v_add_u32 v7, 14024704, v7
  s_cmp_lg_u32 s24, 0
  s_cbranch_scc1 L_pi_8
  global_load_dword v254, v7, s[20:21] sc1
L_pi_8:
  s_waitcnt lgkmcnt(6)
  v_mfma_f32_32x32x16_bf16 v[136:151], v[200:203], v[80:83], v[136:151]
  ds_read_b64_tr_b16 v[200:201], v239 offset:0
  ds_read_b64_tr_b16 v[202:203], v239 offset:768
  s_waitcnt lgkmcnt(6)
  v_mfma_f32_32x32x16_bf16 v[152:167], v[204:207], v[80:83], v[152:167]
  ds_read_b64_tr_b16 v[204:205], v239 offset:12288
  ds_read_b64_tr_b16 v[206:207], v239 offset:13056
  s_waitcnt lgkmcnt(6)
  v_mfma_f32_32x32x16_bf16 v[168:183], v[208:211], v[80:83], v[168:183]
  v_mfma_f32_16x16x32_bf16 v[224:227], v[232:235], v[208:211], v[224:227]
  ds_read_b64_tr_b16 v[208:209], v239 offset:64
  ds_read_b64_tr_b16 v[210:211], v239 offset:832
  s_waitcnt lgkmcnt(6)
  v_mfma_f32_32x32x16_bf16 v[184:199], v[212:215], v[80:83], v[184:199]
  ds_read_b64_tr_b16 v[212:213], v239 offset:12352
  ds_read_b64_tr_b16 v[214:215], v239 offset:13120
  s_waitcnt lgkmcnt(6)
  v_mfma_f32_32x32x16_bf16 v[136:151], v[200:203], v[84:87], v[136:151]
  ds_read_b64_tr_b16 v[200:201], v236 offset:28672
  ds_read_b64_tr_b16 v[202:203], v236 offset:29440
  s_waitcnt lgkmcnt(6)
  v_mfma_f32_32x32x16_bf16 v[152:167], v[204:207], v[84:87], v[152:167]
  ds_read_b64_tr_b16 v[204:205], v236 offset:40960
  ds_read_b64_tr_b16 v[206:207], v236 offset:41728
  s_waitcnt lgkmcnt(6)
  v_mfma_f32_32x32x16_bf16 v[168:183], v[208:211], v[84:87], v[168:183]
  ds_read_b64_tr_b16 v[208:209], v236 offset:28736
  ds_read_b64_tr_b16 v[210:211], v236 offset:29504
  s_waitcnt lgkmcnt(6)
  v_mfma_f32_32x32x16_bf16 v[184:199], v[212:215], v[84:87], v[184:199]
  v_mfma_f32_16x16x32_bf16 v[228:231], v[232:235], v[212:215], v[228:231]
  ds_read_b64_tr_b16 v[212:213], v236 offset:41024
  ds_read_b64_tr_b16 v[214:215], v236 offset:41792
  v_add_u32 v236, 57344, v236
  s_waitcnt lgkmcnt(6)
  v_mfma_f32_32x32x16_bf16 v[136:151], v[200:203], v[88:91], v[136:151]
  v_mfma_f32_16x16x32_bf16 v[216:219], v[232:235], v[200:203], v[216:219]
  ds_read_b64_tr_b16 v[200:201], v237 offset:28672
  ds_read_b64_tr_b16 v[202:203], v237 offset:29440
  s_waitcnt lgkmcnt(6)
  v_mfma_f32_32x32x16_bf16 v[152:167], v[204:207], v[88:91], v[152:167]
  ds_read_b64_tr_b16 v[204:205], v237 offset:40960
  ds_read_b64_tr_b16 v[206:207], v237 offset:41728
  s_waitcnt lgkmcnt(6)
  v_mfma_f32_32x32x16_bf16 v[168:183], v[208:211], v[88:91], v[168:183]
  ds_read_b64_tr_b16 v[208:209], v237 offset:28736
  ds_read_b64_tr_b16 v[210:211], v237 offset:29504
  s_waitcnt lgkmcnt(6)
  v_mfma_f32_32x32x16_bf16 v[184:199], v[212:215], v[88:91], v[184:199]
  ds_read_b64_tr_b16 v[212:213], v237 offset:41024
  ds_read_b64_tr_b16 v[214:215], v237 offset:41792
  v_add_u32 v237, 57344, v237
  s_waitcnt lgkmcnt(6)
  v_mfma_f32_32x32x16_bf16 v[136:151], v[200:203], v[92:95], v[136:151]
  ds_read_b64_tr_b16 v[200:201], v238 offset:28672
  ds_read_b64_tr_b16 v[202:203], v238 offset:29440
  s_waitcnt lgkmcnt(6)
  v_mfma_f32_32x32x16_bf16 v[152:167], v[204:207], v[92:95], v[152:167]
  v_mfma_f32_16x16x32_bf16 v[220:223], v[232:235], v[204:207], v[220:223]
  ds_read_b64_tr_b16 v[204:205], v238 offset:40960
  ds_read_b64_tr_b16 v[206:207], v238 offset:41728
  s_waitcnt lgkmcnt(6)
  v_mfma_f32_32x32x16_bf16 v[168:183], v[208:211], v[92:95], v[168:183]
  ds_read_b64_tr_b16 v[208:209], v238 offset:28736
  ds_read_b64_tr_b16 v[210:211], v238 offset:29504
  s_waitcnt lgkmcnt(6)
  v_mfma_f32_32x32x16_bf16 v[184:199], v[212:215], v[92:95], v[184:199]
  ds_read_b64_tr_b16 v[212:213], v238 offset:41024
  ds_read_b64_tr_b16 v[214:215], v238 offset:41792
  v_add_u32 v238, 57344, v238
  s_barrier
  s_waitcnt lgkmcnt(6)
  v_mfma_f32_32x32x16_bf16 v[136:151], v[200:203], v[96:99], v[136:151]
  ds_read_b64_tr_b16 v[200:201], v239 offset:28672
  ds_read_b64_tr_b16 v[202:203], v239 offset:29440
  s_waitcnt lgkmcnt(6)
  v_mfma_f32_32x32x16_bf16 v[152:167], v[204:207], v[96:99], v[152:167]
  ds_read_b64_tr_b16 v[204:205], v239 offset:40960
  ds_read_b64_tr_b16 v[206:207], v239 offset:41728
  s_waitcnt lgkmcnt(6)
  v_mfma_f32_32x32x16_bf16 v[168:183], v[208:211], v[96:99], v[168:183]
  v_mfma_f32_16x16x32_bf16 v[224:227], v[232:235], v[208:211], v[224:227]
  ds_read_b64_tr_b16 v[208:209], v239 offset:28736
  ds_read_b64_tr_b16 v[210:211], v239 offset:29504
  s_waitcnt lgkmcnt(6)
  v_mfma_f32_32x32x16_bf16 v[184:199], v[212:215], v[96:99], v[184:199]
  ds_read_b64_tr_b16 v[212:213], v239 offset:41024
  ds_read_b64_tr_b16 v[214:215], v239 offset:41792
  v_add_u32 v239, 57344, v239
  s_waitcnt lgkmcnt(6)
  v_mfma_f32_32x32x16_bf16 v[136:151], v[200:203], v[100:103], v[136:151]
  ds_read_b64_tr_b16 v[200:201], v236 offset:0
  ds_read_b64_tr_b16 v[202:203], v236 offset:768
  s_waitcnt lgkmcnt(6)
  v_mfma_f32_32x32x16_bf16 v[152:167], v[204:207], v[100:103], v[152:167]
  ds_read_b64_tr_b16 v[204:205], v236 offset:12288
  ds_read_b64_tr_b16 v[206:207], v236 offset:13056
  s_waitcnt lgkmcnt(6)
  v_mfma_f32_32x32x16_bf16 v[168:183], v[208:211], v[100:103], v[168:183]
  ds_read_b64_tr_b16 v[208:209], v236 offset:64
  ds_read_b64_tr_b16 v[210:211], v236 offset:832
  s_waitcnt lgkmcnt(6)
  v_mfma_f32_32x32x16_bf16 v[184:199], v[212:215], v[100:103], v[184:199]
  v_mfma_f32_16x16x32_bf16 v[228:231], v[232:235], v[212:215], v[228:231]
  ds_read_b64_tr_b16 v[212:213], v236 offset:12352
  ds_read_b64_tr_b16 v[214:215], v236 offset:13120
  s_waitcnt lgkmcnt(6)
  v_mfma_f32_32x32x16_bf16 v[136:151], v[200:203], v[104:107], v[136:151]
  v_mfma_f32_16x16x32_bf16 v[216:219], v[232:235], v[200:203], v[216:219]
  ds_read_b64_tr_b16 v[200:201], v237 offset:0
  ds_read_b64_tr_b16 v[202:203], v237 offset:768
  s_waitcnt lgkmcnt(6)
  v_mfma_f32_32x32x16_bf16 v[152:167], v[204:207], v[104:107], v[152:167]
  ds_read_b64_tr_b16 v[204:205], v237 offset:12288
  ds_read_b64_tr_b16 v[206:207], v237 offset:13056
  s_waitcnt lgkmcnt(6)
  v_mfma_f32_32x32x16_bf16 v[168:183], v[208:211], v[104:107], v[168:183]
  ds_read_b64_tr_b16 v[208:209], v237 offset:64
  ds_read_b64_tr_b16 v[210:211], v237 offset:832
  s_waitcnt lgkmcnt(6)
  v_mfma_f32_32x32x16_bf16 v[184:199], v[212:215], v[104:107], v[184:199]
  ds_read_b64_tr_b16 v[212:213], v237 offset:12352
  ds_read_b64_tr_b16 v[214:215], v237 offset:13120
  s_waitcnt lgkmcnt(6)
  v_mfma_f32_32x32x16_bf16 v[136:151], v[200:203], v[108:111], v[136:151]
  ds_read_b64_tr_b16 v[200:201], v238 offset:0
  ds_read_b64_tr_b16 v[202:203], v238 offset:768
  s_waitcnt lgkmcnt(6)
  v_mfma_f32_32x32x16_bf16 v[152:167], v[204:207], v[108:111], v[152:167]
  v_mfma_f32_16x16x32_bf16 v[220:223], v[232:235], v[204:207], v[220:223]
  ds_read_b64_tr_b16 v[204:205], v238 offset:12288
  ds_read_b64_tr_b16 v[206:207], v238 offset:13056
  s_waitcnt lgkmcnt(6)
  v_mfma_f32_32x32x16_bf16 v[168:183], v[208:211], v[108:111], v[168:183]
  ds_read_b64_tr_b16 v[208:209], v238 offset:64
  ds_read_b64_tr_b16 v[210:211], v238 offset:832
  s_waitcnt lgkmcnt(6)
  v_mfma_f32_32x32x16_bf16 v[184:199], v[212:215], v[108:111], v[184:199]
  ds_read_b64_tr_b16 v[212:213], v238 offset:12352
  ds_read_b64_tr_b16 v[214:215], v238 offset:13120
  s_barrier
  s_cmp_lg_u32 s24, 0
  s_cbranch_scc1 L_kvpf_9
  s_waitcnt vmcnt(0)
  v_cmp_ne_u32 vcc, s3, v254
  s_nop 4
  s_cmp_eq_u64 vcc, 0
  s_cbranch_scc0 L_kvpf_9
  s_lshl_b32 s29, s49, 16
  s_lshl_b32 s30, s50, 13
  s_add_u32 s29, s29, s30
  v_lshlrev_b32 v1, 7, v0
  buffer_load_dword v244, v1, s[20:23], s29 offen
  s_add_u32 s29, s29, 2097152
  buffer_load_dword v245, v1, s[20:23], s29 offen
  s_add_u32 s29, s29, 2097152
  buffer_load_dword v246, v1, s[20:23], s29 offen
  s_mov_b32 s42, 1
L_kvpf_9:
  s_waitcnt lgkmcnt(6)
  v_mfma_f32_32x32x16_bf16 v[136:151], v[200:203], v[112:115], v[136:151]
  ds_read_b64_tr_b16 v[200:201], v239 offset:0
  ds_read_b64_tr_b16 v[202:203], v239 offset:768
  s_waitcnt lgkmcnt(6)
  v_mfma_f32_32x32x16_bf16 v[152:167], v[204:207], v[112:115], v[152:167]
  ds_read_b64_tr_b16 v[204:205], v239 offset:12288
  ds_read_b64_tr_b16 v[206:207], v239 offset:13056
  s_waitcnt lgkmcnt(6)
  v_mfma_f32_32x32x16_bf16 v[168:183], v[208:211], v[112:115], v[168:183]
  v_mfma_f32_16x16x32_bf16 v[224:227], v[232:235], v[208:211], v[224:227]
  ds_read_b64_tr_b16 v[208:209], v239 offset:64
  ds_read_b64_tr_b16 v[210:211], v239 offset:832
  s_waitcnt lgkmcnt(6)
  v_mfma_f32_32x32x16_bf16 v[184:199], v[212:215], v[112:115], v[184:199]
  ds_read_b64_tr_b16 v[212:213], v239 offset:12352
  ds_read_b64_tr_b16 v[214:215], v239 offset:13120
  s_waitcnt lgkmcnt(6)
  v_mfma_f32_32x32x16_bf16 v[136:151], v[200:203], v[116:119], v[136:151]
  ds_read_b64_tr_b16 v[200:201], v236 offset:28672
  ds_read_b64_tr_b16 v[202:203], v236 offset:29440
  s_waitcnt lgkmcnt(6)
  v_mfma_f32_32x32x16_bf16 v[152:167], v[204:207], v[116:119], v[152:167]
  ds_read_b64_tr_b16 v[204:205], v236 offset:40960
  ds_read_b64_tr_b16 v[206:207], v236 offset:41728
  s_waitcnt lgkmcnt(6)
  v_mfma_f32_32x32x16_bf16 v[168:183], v[208:211], v[116:119], v[168:183]
  ds_read_b64_tr_b16 v[208:209], v236 offset:28736
  ds_read_b64_tr_b16 v[210:211], v236 offset:29504
  s_waitcnt lgkmcnt(6)
  v_mfma_f32_32x32x16_bf16 v[184:199], v[212:215], v[116:119], v[184:199]
  v_mfma_f32_16x16x32_bf16 v[228:231], v[232:235], v[212:215], v[228:231]
  ds_read_b64_tr_b16 v[212:213], v236 offset:41024
  ds_read_b64_tr_b16 v[214:215], v236 offset:41792
  v_subrev_u32 v236, 57344, v236
  s_waitcnt lgkmcnt(6)
  v_mfma_f32_32x32x16_bf16 v[136:151], v[200:203], v[120:123], v[136:151]
  v_mfma_f32_16x16x32_bf16 v[216:219], v[232:235], v[200:203], v[216:219]
  ds_read_b64_tr_b16 v[200:201], v237 offset:28672
  ds_read_b64_tr_b16 v[202:203], v237 offset:29440
  s_waitcnt lgkmcnt(6)
  v_mfma_f32_32x32x16_bf16 v[152:167], v[204:207], v[120:123], v[152:167]
  ds_read_b64_tr_b16 v[204:205], v237 offset:40960
  ds_read_b64_tr_b16 v[206:207], v237 offset:41728
  s_waitcnt lgkmcnt(6)
  v_mfma_f32_32x32x16_bf16 v[168:183], v[208:211], v[120:123], v[168:183]
  ds_read_b64_tr_b16 v[208:209], v237 offset:28736
  ds_read_b64_tr_b16 v[210:211], v237 offset:29504
  s_waitcnt lgkmcnt(6)
  v_mfma_f32_32x32x16_bf16 v[184:199], v[212:215], v[120:123], v[184:199]
  ds_read_b64_tr_b16 v[212:213], v237 offset:41024
  ds_read_b64_tr_b16 v[214:215], v237 offset:41792
  v_subrev_u32 v237, 57344, v237
  s_waitcnt lgkmcnt(6)
  v_mfma_f32_32x32x16_bf16 v[136:151], v[200:203], v[124:127], v[136:151]
  ds_read_b64_tr_b16 v[200:201], v238 offset:28672
  ds_read_b64_tr_b16 v[202:203], v238 offset:29440
  s_waitcnt lgkmcnt(6)
  v_mfma_f32_32x32x16_bf16 v[152:167], v[204:207], v[124:127], v[152:167]
  v_mfma_f32_16x16x32_bf16 v[220:223], v[232:235], v[204:207], v[220:223]
  ds_read_b64_tr_b16 v[204:205], v238 offset:40960
  ds_read_b64_tr_b16 v[206:207], v238 offset:41728
  s_waitcnt lgkmcnt(6)
  v_mfma_f32_32x32x16_bf16 v[168:183], v[208:211], v[124:127], v[168:183]
  ds_read_b64_tr_b16 v[208:209], v238 offset:28736
  ds_read_b64_tr_b16 v[210:211], v238 offset:29504
  s_waitcnt lgkmcnt(6)
  v_mfma_f32_32x32x16_bf16 v[184:199], v[212:215], v[124:127], v[184:199]
  ds_read_b64_tr_b16 v[212:213], v238 offset:41024
  ds_read_b64_tr_b16 v[214:215], v238 offset:41792
  v_subrev_u32 v238, 57344, v238
  s_waitcnt lgkmcnt(6)
  v_mfma_f32_32x32x16_bf16 v[136:151], v[200:203], v[128:131], v[136:151]
  ds_read_b64_tr_b16 v[200:201], v239 offset:28672
  ds_read_b64_tr_b16 v[202:203], v239 offset:29440
  s_waitcnt lgkmcnt(6)
  v_mfma_f32_32x32x16_bf16 v[152:167], v[204:207], v[128:131], v[152:167]
  ds_read_b64_tr_b16 v[204:205], v239 offset:40960
  ds_read_b64_tr_b16 v[206:207], v239 offset:41728
  s_waitcnt lgkmcnt(6)
  v_mfma_f32_32x32x16_bf16 v[168:183], v[208:211], v[128:131], v[168:183]
  v_mfma_f32_16x16x32_bf16 v[224:227], v[232:235], v[208:211], v[224:227]
  ds_read_b64_tr_b16 v[208:209], v239 offset:28736
  ds_read_b64_tr_b16 v[210:211], v239 offset:29504
  s_waitcnt lgkmcnt(6)
  v_mfma_f32_32x32x16_bf16 v[184:199], v[212:215], v[128:131], v[184:199]
  ds_read_b64_tr_b16 v[212:213], v239 offset:41024
  ds_read_b64_tr_b16 v[214:215], v239 offset:41792
  v_subrev_u32 v239, 57344, v239
  s_waitcnt lgkmcnt(6)
  v_mfma_f32_32x32x16_bf16 v[136:151], v[200:203], v[132:135], v[136:151]
  s_waitcnt lgkmcnt(4)
  v_mfma_f32_32x32x16_bf16 v[152:167], v[204:207], v[132:135], v[152:167]
  s_waitcnt lgkmcnt(2)
  v_mfma_f32_32x32x16_bf16 v[168:183], v[208:211], v[132:135], v[168:183]
  s_waitcnt lgkmcnt(0)
  v_mfma_f32_32x32x16_bf16 v[184:199], v[212:215], v[132:135], v[184:199]
  v_mfma_f32_16x16x32_bf16 v[228:231], v[232:235], v[212:215], v[228:231]
  s_nop 7
  v_lshlrev_b32 v1, 4, v0
  s_lshl_b32 s29, s25, 2
  s_add_u32 s29, s29, 132096
  v_add_u32 v1, s29, v1
  s_mov_b64 exec, 0xffff
  ds_write_b32 v1, v216 offset:0
  ds_write_b32 v1, v217 offset:256
  ds_write_b32 v1, v220 offset:512
  ds_write_b32 v1, v221 offset:768
  ds_write_b32 v1, v224 offset:1024
  ds_write_b32 v1, v225 offset:1280
  ds_write_b32 v1, v228 offset:1536
  ds_write_b32 v1, v229 offset:1792
  s_mov_b64 exec, -1
  s_cmp_eq_u32 s42, 1
  s_cbranch_scc1 L_ver_10
  s_cmp_lg_u32 s24, 0
  s_cbranch_scc1 L_pok_11
  s_mov_b32 s66, 0
  s_waitcnt vmcnt(0)
L_psp_12:
  v_cmp_ne_u32 vcc, s3, v254
  s_nop 4
  s_cmp_eq_u64 vcc, 0
  s_cbranch_scc1 L_pok_11
  s_add_u32 s66, s66, 1
  s_cmp_gt_u32 s66, 0x8000
  s_cbranch_scc1 L_bail
  s_sleep 1
  global_load_dword v254, v7, s[20:21] sc1
  s_waitcnt vmcnt(0)
  s_branch L_psp_12
L_pok_11:
L_ver_10:
  s_waitcnt lgkmcnt(0)
  s_barrier
  s_lshl_b32 s33, s49, 16
  s_lshl_b32 s55, s50, 3
  s_lshl_b32 s29, s25, 1
  s_add_u32 s55, s55, s29
  s_lshl_b32 s29, s55, 10
  s_add_u32 s69, s33, s29
  s_lshl_b32 s33, s49, 16
  s_lshr_b32 s29, s24, 1
  s_and_b32 s29, s29, 1
  s_and_b32 s30, s24, 1
  s_lshl_b32 s30, s30, 2
  s_lshl_b32 s31, s26, 5
  s_add_u32 s30, s30, s31
  s_lshl_b32 s30, s30, 10
  s_lshl_b32 s31, s29, 16
  s_add_u32 s52, s31, s30
  s_lshl_b32 s31, s29, 21
  s_add_u32 s51, s31, s30
  s_add_u32 s51, s51, s33
  s_add_u32 s51, s51, 2097152
  s_add_u32 s51, s51, 16384
  s_add_u32 s52, s52, 16384
  v_and_b32 v4, 31, v0
  v_lshlrev_b32 v4, 4, v4
  v_add_u32 v4, 132096, v4
  buffer_load_dwordx4 v[216:219], v255, s[20:23], s69 offen sc1
  buffer_load_dwordx4 v[220:223], v255, s[20:23], s69 offen offset:1024 sc1
  ds_read_b128 v[200:203], v4 offset:0
  ds_read_b128 v[204:207], v4 offset:512
  ds_read_b128 v[208:211], v4 offset:1024
  ds_read_b128 v[212:215], v4 offset:1536
  v_mov_b32 v9, 0
  v_mov_b32 v10, 0
  v_mov_b32 v11, 0
  v_mov_b32 v8, v251
  s_waitcnt lgkmcnt(3)
  v_add_f32 v200, v200, v201
  v_add_f32 v202, v202, v203
  v_mov_b32 v203, 0
  v_add_f32 v200, v200, v202
  v_cvt_pk_bf16_f32 v201, v200, v200
  v_lshlrev_b32 v201, 16, v201
  v_sub_f32 v202, v200, v201
  v_cvt_pk_bf16_f32 v200, v201, v202
  v_mov_b32 v201, 0
  v_mov_b32 v202, 0
  s_nop 1
  v_mfma_f32_32x32x16_bf16 v[136:151], v[200:203], v[8:11], v[136:151]
  s_waitcnt lgkmcnt(2)
  v_add_f32 v204, v204, v205
  v_add_f32 v206, v206, v207
  v_mov_b32 v207, 0
  v_add_f32 v204, v204, v206
  v_cvt_pk_bf16_f32 v205, v204, v204
  v_lshlrev_b32 v205, 16, v205
  v_sub_f32 v206, v204, v205
  v_cvt_pk_bf16_f32 v204, v205, v206
  v_mov_b32 v205, 0
  v_mov_b32 v206, 0
  s_nop 1
  v_mfma_f32_32x32x16_bf16 v[152:167], v[204:207], v[8:11], v[152:167]
  s_waitcnt lgkmcnt(1)
  v_add_f32 v208, v208, v209
  v_add_f32 v210, v210, v211
  v_mov_b32 v211, 0
  v_add_f32 v208, v208, v210
  v_cvt_pk_bf16_f32 v209, v208, v208
  v_lshlrev_b32 v209, 16, v209
  v_sub_f32 v210, v208, v209
  v_cvt_pk_bf16_f32 v208, v209, v210
  v_mov_b32 v209, 0
  v_mov_b32 v210, 0
  s_nop 1
  v_mfma_f32_32x32x16_bf16 v[168:183], v[208:211], v[8:11], v[168:183]
  s_waitcnt lgkmcnt(0)
  v_add_f32 v212, v212, v213
  v_add_f32 v214, v214, v215
  v_mov_b32 v215, 0
  v_add_f32 v212, v212, v214
  v_cvt_pk_bf16_f32 v213, v212, v212
  v_lshlrev_b32 v213, 16, v213
  v_sub_f32 v214, v212, v213
  v_cvt_pk_bf16_f32 v212, v213, v214
  v_mov_b32 v213, 0
  v_mov_b32 v214, 0
  s_nop 1
  v_mfma_f32_32x32x16_bf16 v[184:199], v[212:215], v[8:11], v[184:199]
  v_mul_f32 v12, 0xbfb8aa3b, v253
  v_mul_f32 v14, v252, v252
  s_nop 11
  v_pk_mul_f32 v[16:17], v[136:137], v[12:13] op_sel_hi:[1,0]
  v_pk_mul_f32 v[18:19], v[138:139], v[12:13] op_sel_hi:[1,0]
  v_pk_mul_f32 v[20:21], v[140:141], v[12:13] op_sel_hi:[1,0]
  v_pk_mul_f32 v[22:23], v[142:143], v[12:13] op_sel_hi:[1,0]
  v_pk_mul_f32 v[24:25], v[144:145], v[12:13] op_sel_hi:[1,0]
  v_pk_mul_f32 v[26:27], v[146:147], v[12:13] op_sel_hi:[1,0]
  v_pk_mul_f32 v[28:29], v[148:149], v[12:13] op_sel_hi:[1,0]
  v_pk_mul_f32 v[30:31], v[150:151], v[12:13] op_sel_hi:[1,0]
  v_exp_f32 v16, v16
  v_exp_f32 v17, v17
  v_exp_f32 v18, v18
  v_exp_f32 v19, v19
  v_exp_f32 v20, v20
  v_exp_f32 v21, v21
  v_exp_f32 v22, v22
  v_exp_f32 v23, v23
  v_exp_f32 v24, v24
  v_exp_f32 v25, v25
  v_exp_f32 v26, v26
  v_exp_f32 v27, v27
  v_exp_f32 v28, v28
  v_exp_f32 v29, v29
  v_exp_f32 v30, v30
  v_exp_f32 v31, v31
  v_pk_mul_f32 v[136:137], v[136:137], v[152:153]
  v_pk_mul_f32 v[138:139], v[138:139], v[154:155]
  v_pk_mul_f32 v[140:141], v[140:141], v[156:157]
  v_pk_mul_f32 v[142:143], v[142:143], v[158:159]
  v_pk_mul_f32 v[144:145], v[144:145], v[160:161]
  v_pk_mul_f32 v[146:147], v[146:147], v[162:163]
  v_pk_mul_f32 v[148:149], v[148:149], v[164:165]
  v_pk_mul_f32 v[150:151], v[150:151], v[166:167]
  v_pk_fma_f32 v[16:17], v[16:17], v[14:15], v[14:15] op_sel_hi:[1,0,0]
  v_pk_fma_f32 v[18:19], v[18:19], v[14:15], v[14:15] op_sel_hi:[1,0,0]
  v_pk_fma_f32 v[20:21], v[20:21], v[14:15], v[14:15] op_sel_hi:[1,0,0]
  v_pk_fma_f32 v[22:23], v[22:23], v[14:15], v[14:15] op_sel_hi:[1,0,0]
  v_pk_fma_f32 v[24:25], v[24:25], v[14:15], v[14:15] op_sel_hi:[1,0,0]
  v_pk_fma_f32 v[26:27], v[26:27], v[14:15], v[14:15] op_sel_hi:[1,0,0]
  v_pk_fma_f32 v[28:29], v[28:29], v[14:15], v[14:15] op_sel_hi:[1,0,0]
  v_pk_fma_f32 v[30:31], v[30:31], v[14:15], v[14:15] op_sel_hi:[1,0,0]
  v_rcp_f32 v16, v16
  v_rcp_f32 v17, v17
  v_rcp_f32 v18, v18
  v_rcp_f32 v19, v19
  v_rcp_f32 v20, v20
  v_rcp_f32 v21, v21
  v_rcp_f32 v22, v22
  v_rcp_f32 v23, v23
  v_rcp_f32 v24, v24
  v_rcp_f32 v25, v25
  v_rcp_f32 v26, v26
  v_rcp_f32 v27, v27
  v_rcp_f32 v28, v28
  v_rcp_f32 v29, v29
  v_rcp_f32 v30, v30
  v_rcp_f32 v31, v31
  s_nop 0
  v_pk_mul_f32 v[136:137], v[136:137], v[16:17]
  v_pk_mul_f32 v[138:139], v[138:139], v[18:19]
  v_pk_mul_f32 v[140:141], v[140:141], v[20:21]
  v_pk_mul_f32 v[142:143], v[142:143], v[22:23]
  v_pk_mul_f32 v[144:145], v[144:145], v[24:25]
  v_pk_mul_f32 v[146:147], v[146:147], v[26:27]
  v_pk_mul_f32 v[148:149], v[148:149], v[28:29]
  v_pk_mul_f32 v[150:151], v[150:151], v[30:31]
  v_cvt_pk_bf16_f32 v32, v136, v137
  v_cvt_pk_bf16_f32 v33, v138, v139
  v_cvt_pk_bf16_f32 v34, v140, v141
  v_cvt_pk_bf16_f32 v35, v142, v143
  v_cvt_pk_bf16_f32 v36, v144, v145
  v_cvt_pk_bf16_f32 v37, v146, v147
  v_cvt_pk_bf16_f32 v38, v148, v149
  v_cvt_pk_bf16_f32 v39, v150, v151
  v_pk_mul_f32 v[48:49], v[168:169], v[12:13] op_sel_hi:[1,0]
  v_pk_mul_f32 v[50:51], v[170:171], v[12:13] op_sel_hi:[1,0]
  v_pk_mul_f32 v[52:53], v[172:173], v[12:13] op_sel_hi:[1,0]
  v_pk_mul_f32 v[54:55], v[174:175], v[12:13] op_sel_hi:[1,0]
  v_pk_mul_f32 v[56:57], v[176:177], v[12:13] op_sel_hi:[1,0]
  v_pk_mul_f32 v[58:59], v[178:179], v[12:13] op_sel_hi:[1,0]
  v_pk_mul_f32 v[60:61], v[180:181], v[12:13] op_sel_hi:[1,0]
  v_pk_mul_f32 v[62:63], v[182:183], v[12:13] op_sel_hi:[1,0]
  v_exp_f32 v48, v48
  v_exp_f32 v49, v49
  v_exp_f32 v50, v50
  v_exp_f32 v51, v51
  v_exp_f32 v52, v52
  v_exp_f32 v53, v53
  v_exp_f32 v54, v54
  v_exp_f32 v55, v55
  v_exp_f32 v56, v56
  v_exp_f32 v57, v57
  v_exp_f32 v58, v58
  v_exp_f32 v59, v59
  v_exp_f32 v60, v60
  v_exp_f32 v61, v61
  v_exp_f32 v62, v62
  v_exp_f32 v63, v63
  v_pk_mul_f32 v[168:169], v[168:169], v[184:185]
  v_pk_mul_f32 v[170:171], v[170:171], v[186:187]
  v_pk_mul_f32 v[172:173], v[172:173], v[188:189]
  v_pk_mul_f32 v[174:175], v[174:175], v[190:191]
  v_pk_mul_f32 v[176:177], v[176:177], v[192:193]
  v_pk_mul_f32 v[178:179], v[178:179], v[194:195]
  v_pk_mul_f32 v[180:181], v[180:181], v[196:197]
  v_pk_mul_f32 v[182:183], v[182:183], v[198:199]
  v_pk_fma_f32 v[48:49], v[48:49], v[14:15], v[14:15] op_sel_hi:[1,0,0]
  v_pk_fma_f32 v[50:51], v[50:51], v[14:15], v[14:15] op_sel_hi:[1,0,0]
  v_pk_fma_f32 v[52:53], v[52:53], v[14:15], v[14:15] op_sel_hi:[1,0,0]
  v_pk_fma_f32 v[54:55], v[54:55], v[14:15], v[14:15] op_sel_hi:[1,0,0]
  v_pk_fma_f32 v[56:57], v[56:57], v[14:15], v[14:15] op_sel_hi:[1,0,0]
  v_pk_fma_f32 v[58:59], v[58:59], v[14:15], v[14:15] op_sel_hi:[1,0,0]
  v_pk_fma_f32 v[60:61], v[60:61], v[14:15], v[14:15] op_sel_hi:[1,0,0]
  v_pk_fma_f32 v[62:63], v[62:63], v[14:15], v[14:15] op_sel_hi:[1,0,0]
  v_rcp_f32 v48, v48
  v_rcp_f32 v49, v49
  v_rcp_f32 v50, v50
  v_rcp_f32 v51, v51
  v_rcp_f32 v52, v52
  v_rcp_f32 v53, v53
  v_rcp_f32 v54, v54
  v_rcp_f32 v55, v55
  v_rcp_f32 v56, v56
  v_rcp_f32 v57, v57
  v_rcp_f32 v58, v58
  v_rcp_f32 v59, v59
  v_rcp_f32 v60, v60
  v_rcp_f32 v61, v61
  v_rcp_f32 v62, v62
  v_rcp_f32 v63, v63
  s_nop 0
  v_pk_mul_f32 v[168:169], v[168:169], v[48:49]
  v_pk_mul_f32 v[170:171], v[170:171], v[50:51]
  v_pk_mul_f32 v[172:173], v[172:173], v[52:53]
  v_pk_mul_f32 v[174:175], v[174:175], v[54:55]
  v_pk_mul_f32 v[176:177], v[176:177], v[56:57]
  v_pk_mul_f32 v[178:179], v[178:179], v[58:59]
  v_pk_mul_f32 v[180:181], v[180:181], v[60:61]
  v_pk_mul_f32 v[182:183], v[182:183], v[62:63]
  v_cvt_pk_bf16_f32 v64, v168, v169
  v_cvt_pk_bf16_f32 v65, v170, v171
  v_cvt_pk_bf16_f32 v66, v172, v173
  v_cvt_pk_bf16_f32 v67, v174, v175
  v_cvt_pk_bf16_f32 v68, v176, v177
  v_cvt_pk_bf16_f32 v69, v178, v179
  v_cvt_pk_bf16_f32 v70, v180, v181
  v_cvt_pk_bf16_f32 v71, v182, v183
  s_mul_i32 s29, s27, 3
  s_add_u32 s29, s29, 0
  s_mul_i32 s30, s48, 86
  s_lshl_b32 s31, s29, 1
  s_add_u32 s30, s30, s31
  s_lshl_b32 s30, s30, 10
  s_add_u32 s30, s30, 6291456
  s_cmp_ge_u32 s29, 43
  s_cselect_b32 s30, 14024704, s30
  buffer_store_dwordx4 v[32:35], v255, s[20:23], s30 offen sc1
  buffer_store_dwordx4 v[36:39], v255, s[20:23], s30 offen offset:1024 sc1
  s_mul_i32 s29, s27, 3
  s_add_u32 s29, s29, 1
  s_mul_i32 s30, s48, 86
  s_lshl_b32 s31, s29, 1
  s_add_u32 s30, s30, s31
  s_lshl_b32 s30, s30, 10
  s_add_u32 s30, s30, 6291456
  s_cmp_ge_u32 s29, 43
  s_cselect_b32 s30, 14024704, s30
  buffer_store_dwordx4 v[64:67], v255, s[20:23], s30 offen sc1
  buffer_store_dwordx4 v[68:71], v255, s[20:23], s30 offen offset:1024 sc1
  s_branch L_join
L_uh1:
  s_add_u32 m0, s44, 0
  s_mov_b32 s29, 0
  buffer_load_dwordx4 v244, s[8:11], s29 offen lds
  s_add_u32 m0, s45, 0
  s_add_u32 s29, s35, 0
  buffer_load_dwordx4 v246, s[12:15], s29 offen lds
  s_add_u32 m0, s44, 1024
  s_mov_b32 s29, 0
  buffer_load_dwordx4 v245, s[8:11], s29 offen lds
  s_add_u32 m0, s45, 1024
  s_add_u32 s29, s35, 0
  buffer_load_dwordx4 v247, s[12:15], s29 offen lds
  s_add_u32 m0, s44, 2048
  s_mov_b32 s29, 16384
  buffer_load_dwordx4 v244, s[8:11], s29 offen lds
  s_add_u32 m0, s45, 2048
  s_add_u32 s29, s35, 0
  buffer_load_dwordx4 v248, s[12:15], s29 offen lds
  s_add_u32 m0, s44, 3072
  s_mov_b32 s29, 16384
  buffer_load_dwordx4 v245, s[8:11], s29 offen lds
  s_add_u32 m0, s44, 28672
  s_mov_b32 s29, 128
  buffer_load_dwordx4 v244, s[8:11], s29 offen lds
  s_add_u32 m0, s45, 28672
  s_add_u32 s29, s35, 196608
  buffer_load_dwordx4 v246, s[12:15], s29 offen lds
  s_add_u32 m0, s44, 29696
  s_mov_b32 s29, 128
  buffer_load_dwordx4 v245, s[8:11], s29 offen lds
  s_add_u32 m0, s45, 29696
  s_add_u32 s29, s35, 196608
  buffer_load_dwordx4 v247, s[12:15], s29 offen lds
  s_add_u32 m0, s44, 30720
  s_mov_b32 s29, 16512
  buffer_load_dwordx4 v244, s[8:11], s29 offen lds
  s_add_u32 m0, s45, 30720
  s_add_u32 s29, s35, 196608
  buffer_load_dwordx4 v248, s[12:15], s29 offen lds
  s_add_u32 m0, s44, 31744
  s_mov_b32 s29, 16512
  buffer_load_dwordx4 v245, s[8:11], s29 offen lds
  s_add_u32 m0, s44, 57344
  s_mov_b32 s29, 256
  buffer_load_dwordx4 v244, s[8:11], s29 offen lds
  s_add_u32 m0, s45, 57344
  s_add_u32 s29, s35, 393216
  buffer_load_dwordx4 v246, s[12:15], s29 offen lds
  s_add_u32 m0, s44, 58368
  s_mov_b32 s29, 256
  buffer_load_dwordx4 v245, s[8:11], s29 offen lds
  s_add_u32 m0, s45, 58368
  s_add_u32 s29, s35, 393216
  buffer_load_dwordx4 v247, s[12:15], s29 offen lds
  s_add_u32 m0, s44, 59392
  s_mov_b32 s29, 16640
  buffer_load_dwordx4 v244, s[8:11], s29 offen lds
  s_add_u32 m0, s45, 59392
  s_add_u32 s29, s35, 393216
  buffer_load_dwordx4 v248, s[12:15], s29 offen lds
  s_add_u32 m0, s44, 60416
  s_mov_b32 s29, 16640
  buffer_load_dwordx4 v245, s[8:11], s29 offen lds
  s_mov_b32 s16, s60
  s_mov_b32 s17, s61
  s_mov_b32 s18, 1409024
  s_mov_b32 s19, 0x20000
  s_mov_b32 s20, s68
  s_mov_b32 s21, s69
  s_mov_b32 s22, 14024704
  s_mov_b32 s23, 0x20000
  s_mov_b32 s36, s64
  s_mov_b32 s37, s65
  s_mov_b32 s42, 0
  s_add_u32 s30, s68, 14036992
  s_addc_u32 s31, s69, 0
  s_load_dword s3, s[30:31], 0
  s_mov_b32 s4, s62
  s_mov_b32 s5, s63
  s_mov_b32 s6, 1409024
  s_mov_b32 s7, 0x20000
  s_movk_i32 s33, 2752
  s_mov_b32 s32, 43691
  v_add_u32 v1, 0, v0
  v_mul_u32_u24 v2, s32, v1
  v_lshrrev_b32 v2, 19, v2
  v_mul_u32_u24 v3, 12, v2
  v_sub_u32 v3, v1, v3
  v_mov_b32 v4, v3
  v_mul_u32_u24 v2, s33, v2
  v_lshl_add_u32 v232, v4, 4, v2
  v_lshrrev_b32 v3, 2, v3
  s_mul_i32 s29, s27, 3
  v_add_u32 v3, s29, v3
  v_cmp_lt_u32 vcc, 42, v3
  v_mov_b32 v2, 0x7ff00000
  s_nop 0
  v_cndmask_b32 v232, v232, v2, vcc
  v_add_u32 v1, 64, v0
  v_mul_u32_u24 v2, s32, v1
  v_lshrrev_b32 v2, 19, v2
  v_mul_u32_u24 v3, 12, v2
  v_sub_u32 v3, v1, v3
  v_mov_b32 v4, v3
  v_mul_u32_u24 v2, s33, v2
  v_lshl_add_u32 v233, v4, 4, v2
  v_lshrrev_b32 v3, 2, v3
  s_mul_i32 s29, s27, 3
  v_add_u32 v3, s29, v3
  v_cmp_lt_u32 vcc, 42, v3
  v_mov_b32 v2, 0x7ff00000
  s_nop 0
  v_cndmask_b32 v233, v233, v2, vcc
  v_add_u32 v1, 128, v0
  v_mul_u32_u24 v2, s32, v1
  v_lshrrev_b32 v2, 19, v2
  v_mul_u32_u24 v3, 12, v2
  v_sub_u32 v3, v1, v3
  v_mov_b32 v4, v3
  v_mul_u32_u24 v2, s33, v2
  v_lshl_add_u32 v234, v4, 4, v2
  v_lshrrev_b32 v3, 2, v3
  s_mul_i32 s29, s27, 3
  v_add_u32 v3, s29, v3
  v_cmp_lt_u32 vcc, 42, v3
  v_mov_b32 v2, 0x7ff00000
  s_nop 0
  v_cndmask_b32 v234, v234, v2, vcc
  s_mul_i32 s31, s27, 192
  s_mul_i32 s46, s25, 3072
  s_mul_i32 s29, s25, 44032
  s_add_u32 s47, s29, s31
  v_and_b32 v1, 31, v0
  v_lshrrev_b32 v2, 5, v0
  s_lshl_b32 s29, s25, 5
  v_add_u32 v3, s29, v1
  v_lshlrev_b32 v3, 7, v3
  v_lshlrev_b32 v4, 2, v2
  v_or_b32 v4, s25, v4
  v_bfe_u32 v5, v1, 1, 3
  v_xor_b32 v4, v4, v5
  v_lshl_add_u32 v240, v4, 4, v3
  v_xor_b32 v241, 16, v240
  v_xor_b32 v242, 32, v240
  v_xor_b32 v243, 48, v240
  v_lshlrev_b32 v3, 5, v2
  v_bfe_u32 v4, v0, 2, 2
  v_add_u32 v3, v3, v4
  v_mul_u32_u24 v3, 0xc0, v3
  v_bfe_u32 v4, v0, 4, 1
  v_lshl_add_u32 v3, v4, 5, v3
  v_and_b32 v4, 3, v0
  v_lshl_add_u32 v3, v4, 3, v3
  s_xor_b32 s29, s25, 0
  s_mul_i32 s29, s29, 1536
  v_add_u32 v236, s29, v3
  s_xor_b32 s29, s25, 1
  s_mul_i32 s29, s29, 1536
  v_add_u32 v237, s29, v3
  s_xor_b32 s29, s25, 2
  s_mul_i32 s29, s29, 1536
  v_add_u32 v238, s29, v3
  s_xor_b32 s29, s25, 3
  s_mul_i32 s29, s29, 1536
  v_add_u32 v239, s29, v3
  s_mov_b32 s34, 0xffff0000
  s_waitcnt lgkmcnt(0)
  s_mul_i32 s3, s3, 0x9E3779B1
  s_add_u32 s3, s3, 0x7F4A7C15
  s_waitcnt vmcnt(14)
  s_barrier
  ds_read_b128 v[8:11], v240 offset:0
  ds_read_b128 v[12:15], v241 offset:0
  s_waitcnt vmcnt(7)
  s_barrier
  ds_read_b128 v[16:19], v242 offset:0
  s_add_u32 m0, s44, 86016
  s_mov_b32 s29, 384
  buffer_load_dwordx4 v244, s[8:11], s29 offen lds
  s_add_u32 m0, s45, 86016
  s_add_u32 s29, s35, 589824
  buffer_load_dwordx4 v246, s[12:15], s29 offen lds
  ds_read_b128 v[20:23], v243 offset:0
  s_add_u32 m0, s44, 87040
  s_mov_b32 s29, 384
  buffer_load_dwordx4 v245, s[8:11], s29 offen lds
  s_add_u32 m0, s45, 87040
  s_add_u32 s29, s35, 589824
  buffer_load_dwordx4 v247, s[12:15], s29 offen lds
  ds_read_b128 v[24:27], v240 offset:28672
  v_add_u32 v240, 57344, v240
  s_add_u32 m0, s44, 88064
  s_mov_b32 s29, 16768
  buffer_load_dwordx4 v244, s[8:11], s29 offen lds
  s_add_u32 m0, s45, 88064
  s_add_u32 s29, s35, 589824
  buffer_load_dwordx4 v248, s[12:15], s29 offen lds
  ds_read_b128 v[28:31], v241 offset:28672
  v_add_u32 v241, 57344, v241
  s_add_u32 m0, s44, 89088
  s_mov_b32 s29, 16768
  buffer_load_dwordx4 v245, s[8:11], s29 offen lds
  s_waitcnt lgkmcnt(2)
  s_waitcnt vmcnt(7)
  s_barrier
  ds_read_b128 v[32:35], v242 offset:28672
  v_add_u32 v242, 57344, v242
  s_add_u32 m0, s44, 0
  s_mov_b32 s29, 512
  buffer_load_dwordx4 v244, s[8:11], s29 offen lds
  s_add_u32 m0, s45, 0
  s_add_u32 s29, s35, 786432
  buffer_load_dwordx4 v246, s[12:15], s29 offen lds
  ds_read_b128 v[36:39], v243 offset:28672
  v_add_u32 v243, 57344, v243
  s_add_u32 m0, s44, 1024
  s_mov_b32 s29, 512
  buffer_load_dwordx4 v245, s[8:11], s29 offen lds
  s_add_u32 m0, s45, 1024
  s_add_u32 s29, s35, 786432
  buffer_load_dwordx4 v247, s[12:15], s29 offen lds
  ds_read_b128 v[40:43], v240 offset:0
  s_add_u32 m0, s44, 2048
  s_mov_b32 s29, 16896
  buffer_load_dwordx4 v244, s[8:11], s29 offen lds
  s_add_u32 m0, s45, 2048
  s_add_u32 s29, s35, 786432
  buffer_load_dwordx4 v248, s[12:15], s29 offen lds
  ds_read_b128 v[44:47], v241 offset:0
  s_add_u32 m0, s44, 3072
  s_mov_b32 s29, 16896
  buffer_load_dwordx4 v245, s[8:11], s29 offen lds
  s_waitcnt lgkmcnt(2)
  s_waitcnt vmcnt(7)
  s_barrier
  ds_read_b128 v[48:51], v242 offset:0
  s_add_u32 m0, s44, 28672
  s_mov_b32 s29, 640
  buffer_load_dwordx4 v244, s[8:11], s29 offen lds
  s_add_u32 m0, s45, 28672
  s_add_u32 s29, s35, 983040
  buffer_load_dwordx4 v246, s[12:15], s29 offen lds
  ds_read_b128 v[52:55], v243 offset:0
  s_add_u32 m0, s44, 29696
  s_mov_b32 s29, 640
  buffer_load_dwordx4 v245, s[8:11], s29 offen lds
  s_add_u32 m0, s45, 29696
  s_add_u32 s29, s35, 983040
  buffer_load_dwordx4 v247, s[12:15], s29 offen lds
  ds_read_b128 v[56:59], v240 offset:28672
  v_subrev_u32 v240, 57344, v240
  s_add_u32 m0, s44, 30720
  s_mov_b32 s29, 17024
  buffer_load_dwordx4 v244, s[8:11], s29 offen lds
  s_add_u32 m0, s45, 30720
  s_add_u32 s29, s35, 983040
  buffer_load_dwordx4 v248, s[12:15], s29 offen lds
  ds_read_b128 v[60:63], v241 offset:28672
  v_subrev_u32 v241, 57344, v241
  s_add_u32 m0, s44, 31744
  s_mov_b32 s29, 17024
  buffer_load_dwordx4 v245, s[8:11], s29 offen lds
  s_waitcnt lgkmcnt(2)
  s_waitcnt vmcnt(7)
  s_barrier
  ds_read_b128 v[64:67], v242 offset:28672
  v_subrev_u32 v242, 57344, v242
  s_add_u32 m0, s44, 57344
  s_mov_b32 s29, 768
  buffer_load_dwordx4 v244, s[8:11], s29 offen lds
  s_add_u32 m0, s45, 57344
  s_add_u32 s29, s35, 1179648
  buffer_load_dwordx4 v246, s[12:15], s29 offen lds
  ds_read_b128 v[68:71], v243 offset:28672
  v_subrev_u32 v243, 57344, v243
  s_add_u32 m0, s44, 58368
  s_mov_b32 s29, 768
  buffer_load_dwordx4 v245, s[8:11], s29 offen lds
  s_add_u32 m0, s45, 58368
  s_add_u32 s29, s35, 1179648
  buffer_load_dwordx4 v247, s[12:15], s29 offen lds
  ds_read_b128 v[72:75], v240 offset:0
  s_add_u32 m0, s44, 59392
  s_mov_b32 s29, 17152
  buffer_load_dwordx4 v244, s[8:11], s29 offen lds
  s_add_u32 m0, s45, 59392
  s_add_u32 s29, s35, 1179648
  buffer_load_dwordx4 v248, s[12:15], s29 offen lds
  ds_read_b128 v[76:79], v241 offset:0
  s_add_u32 m0, s44, 60416
  s_mov_b32 s29, 17152
  buffer_load_dwordx4 v245, s[8:11], s29 offen lds
  s_waitcnt lgkmcnt(2)
  s_waitcnt vmcnt(7)
  s_barrier
  ds_read_b128 v[80:83], v242 offset:0
  s_add_u32 m0, s44, 86016
  s_mov_b32 s29, 896
  buffer_load_dwordx4 v244, s[8:11], s29 offen lds
  s_add_u32 m0, s45, 86016
  s_add_u32 s29, s35, 1376256
  buffer_load_dwordx4 v246, s[12:15], s29 offen lds
  ds_read_b128 v[84:87], v243 offset:0
  s_add_u32 m0, s44, 87040
  s_mov_b32 s29, 896
  buffer_load_dwordx4 v245, s[8:11], s29 offen lds
  s_add_u32 m0, s45, 87040
  s_add_u32 s29, s35, 1376256
  buffer_load_dwordx4 v247, s[12:15], s29 offen lds
  ds_read_b128 v[88:91], v240 offset:28672
  v_add_u32 v240, 57344, v240
  s_add_u32 m0, s44, 88064
  s_mov_b32 s29, 17280
  buffer_load_dwordx4 v244, s[8:11], s29 offen lds
  s_add_u32 m0, s45, 88064
  s_add_u32 s29, s35, 1376256
  buffer_load_dwordx4 v248, s[12:15], s29 offen lds
  ds_read_b128 v[92:95], v241 offset:28672
  v_add_u32 v241, 57344, v241
  s_add_u32 m0, s44, 89088
  s_mov_b32 s29, 17280
  buffer_load_dwordx4 v245, s[8:11], s29 offen lds
  s_waitcnt lgkmcnt(2)
  s_waitcnt vmcnt(7)
  s_barrier
  ds_read_b128 v[96:99], v242 offset:28672
  v_add_u32 v242, 57344, v242
  s_add_u32 m0, s46, 0
  s_add_u32 s29, s47, 0
  buffer_load_dwordx4 v232, s[16:19], s29 offen lds
  s_add_u32 m0, s46, 12288
  s_add_u32 s29, s47, 0
  buffer_load_dwordx4 v232, s[4:7], s29 offen lds
  ds_read_b128 v[100:103], v243 offset:28672
  v_add_u32 v243, 57344, v243
  s_add_u32 m0, s46, 1024
  s_add_u32 s29, s47, 0
  buffer_load_dwordx4 v233, s[16:19], s29 offen lds
  s_add_u32 m0, s46, 13312
  s_add_u32 s29, s47, 0
  buffer_load_dwordx4 v233, s[4:7], s29 offen lds
  ds_read_b128 v[104:107], v240 offset:0
  s_add_u32 m0, s46, 2048
  s_add_u32 s29, s47, 0
  buffer_load_dwordx4 v234, s[16:19], s29 offen lds
  s_add_u32 m0, s46, 14336
  s_add_u32 s29, s47, 0
  buffer_load_dwordx4 v234, s[4:7], s29 offen lds
  ds_read_b128 v[108:111], v241 offset:0
  s_waitcnt lgkmcnt(2)
  s_waitcnt vmcnt(6)
  s_barrier
  ds_read_b128 v[112:115], v242 offset:0
  s_add_u32 m0, s46, 28672
  s_add_u32 s29, s47, 176128
  buffer_load_dwordx4 v232, s[16:19], s29 offen lds
  s_add_u32 m0, s46, 40960
  s_add_u32 s29, s47, 176128
  buffer_load_dwordx4 v232, s[4:7], s29 offen lds
  ds_read_b128 v[116:119], v243 offset:0
  s_add_u32 m0, s46, 29696
  s_add_u32 s29, s47, 176128
  buffer_load_dwordx4 v233, s[16:19], s29 offen lds
  s_add_u32 m0, s46, 41984
  s_add_u32 s29, s47, 176128
  buffer_load_dwordx4 v233, s[4:7], s29 offen lds
  ds_read_b128 v[120:123], v240 offset:28672
  v_subrev_u32 v240, 57344, v240
  s_add_u32 m0, s46, 30720
  s_add_u32 s29, s47, 176128
  buffer_load_dwordx4 v234, s[16:19], s29 offen lds
  s_add_u32 m0, s46, 43008
  s_add_u32 s29, s47, 176128
  buffer_load_dwordx4 v234, s[4:7], s29 offen lds
  ds_read_b128 v[124:127], v241 offset:28672
  v_subrev_u32 v241, 57344, v241
  s_waitcnt lgkmcnt(2)
  s_waitcnt vmcnt(6)
  s_barrier
  ds_read_b128 v[128:131], v242 offset:28672
  v_subrev_u32 v242, 57344, v242
  s_add_u32 m0, s46, 57344
  s_add_u32 s29, s47, 352256
  buffer_load_dwordx4 v232, s[16:19], s29 offen lds
  s_add_u32 m0, s46, 69632
  s_add_u32 s29, s47, 352256
  buffer_load_dwordx4 v232, s[4:7], s29 offen lds
  ds_read_b128 v[132:135], v243 offset:28672
  v_subrev_u32 v243, 57344, v243
  s_add_u32 m0, s46, 58368
  s_add_u32 s29, s47, 352256
  buffer_load_dwordx4 v233, s[16:19], s29 offen lds
  s_add_u32 m0, s46, 70656
  s_add_u32 s29, s47, 352256
  buffer_load_dwordx4 v233, s[4:7], s29 offen lds
  s_add_u32 m0, s46, 59392
  s_add_u32 s29, s47, 352256
  buffer_load_dwordx4 v234, s[16:19], s29 offen lds
  s_add_u32 m0, s46, 71680
  s_add_u32 s29, s47, 352256
  buffer_load_dwordx4 v234, s[4:7], s29 offen lds
  s_waitcnt lgkmcnt(0)
  s_barrier
  v_and_b32 v1, 31, v0
  s_lshl_b32 s29, s25, 5
  v_add_u32 v1, s29, v1
  v_lshlrev_b32 v1, 3, v1
  v_add_u32 v1, 131072, v1
  ds_read_b64 v[2:3], v1
  v_cmp_gt_u32 vcc, 32, v0
  s_waitcnt lgkmcnt(0)
  v_mov_b32 v252, v3
  v_rcp_f32 v253, v3
  v_cndmask_b32 v251, 0, v2, vcc
  s_nop 1
  ds_read_b64_tr_b16 v[200:201], v236 offset:128
  ds_read_b64_tr_b16 v[202:203], v236 offset:896
  ds_read_b64_tr_b16 v[204:205], v236 offset:12416
  ds_read_b64_tr_b16 v[206:207], v236 offset:13184
  ds_read_b64_tr_b16 v[208:209], v237 offset:128
  ds_read_b64_tr_b16 v[210:211], v237 offset:896
  ds_read_b64_tr_b16 v[212:213], v237 offset:12416
  ds_read_b64_tr_b16 v[214:215], v237 offset:13184
  v_mov_b32 v136, 0
  v_mov_b32 v137, 0
  v_mov_b32 v138, 0
  v_mov_b32 v139, 0
  v_mov_b32 v140, 0
  v_mov_b32 v141, 0
  v_mov_b32 v142, 0
  v_mov_b32 v143, 0
  v_mov_b32 v144, 0
  v_mov_b32 v145, 0
  v_mov_b32 v146, 0
  v_mov_b32 v147, 0
  v_mov_b32 v148, 0
  v_mov_b32 v149, 0
  v_mov_b32 v150, 0
  v_mov_b32 v151, 0
  v_mov_b32 v152, 0
  v_mov_b32 v153, 0
  v_mov_b32 v154, 0
  v_mov_b32 v155, 0
  v_mov_b32 v156, 0
  v_mov_b32 v157, 0
  v_mov_b32 v158, 0
  v_mov_b32 v159, 0
  v_mov_b32 v160, 0
  v_mov_b32 v161, 0
  v_mov_b32 v162, 0
  v_mov_b32 v163, 0
  v_mov_b32 v164, 0
  v_mov_b32 v165, 0
  v_mov_b32 v166, 0
  v_mov_b32 v167, 0
  v_mov_b32 v216, 0
  v_mov_b32 v217, 0
  v_mov_b32 v218, 0
  v_mov_b32 v219, 0
  v_mov_b32 v220, 0
  v_mov_b32 v221, 0
  v_mov_b32 v222, 0
  v_mov_b32 v223, 0
  v_and_b32 v1, 15, v0
  v_bfe_u32 v2, v0, 4, 1
  v_cmp_eq_u32 vcc, v1, v2
  v_mov_b32 v3, 0x3f803f80
  s_nop 0
  v_cndmask_b32 v184, 0, v3, vcc
  v_mov_b32 v185, v184
  v_mov_b32 v186, v184
  v_mov_b32 v187, v184
  ds_read_b64_tr_b16 v[176:177], v238 offset:128
  ds_read_b64_tr_b16 v[178:179], v238 offset:896
  ds_read_b64_tr_b16 v[180:181], v238 offset:12416
  ds_read_b64_tr_b16 v[182:183], v238 offset:13184
  s_waitcnt lgkmcnt(8)
  v_mfma_f32_32x32x16_bf16 v[136:151], v[200:203], v[8:11], v[136:151]
  v_mfma_f32_32x32x16_bf16 v[152:167], v[204:207], v[8:11], v[152:167]
  v_mfma_f32_16x16x32_bf16 v[216:219], v[184:187], v[200:203], v[216:219]
  ds_read_b64_tr_b16 v[200:201], v239 offset:128
  ds_read_b64_tr_b16 v[202:203], v239 offset:896
  ds_read_b64_tr_b16 v[204:205], v239 offset:12416
  ds_read_b64_tr_b16 v[206:207], v239 offset:13184
  s_waitcnt lgkmcnt(8)
  v_mfma_f32_32x32x16_bf16 v[136:151], v[208:211], v[12:15], v[136:151]
  v_mfma_f32_32x32x16_bf16 v[152:167], v[212:215], v[12:15], v[152:167]
  v_mfma_f32_16x16x32_bf16 v[220:223], v[184:187], v[212:215], v[220:223]
  s_waitcnt vmcnt(6)
  s_barrier
  ds_read_b64_tr_b16 v[208:209], v236 offset:28800
  ds_read_b64_tr_b16 v[210:211], v236 offset:29568
  ds_read_b64_tr_b16 v[212:213], v236 offset:41088
  ds_read_b64_tr_b16 v[214:215], v236 offset:41856
  v_add_u32 v236, 57344, v236
  s_waitcnt lgkmcnt(8)
  v_mfma_f32_32x32x16_bf16 v[136:151], v[176:179], v[16:19], v[136:151]
  s_add_u32 m0, s46, 86016
  s_add_u32 s29, s47, 528384
  buffer_load_dwordx4 v232, s[16:19], s29 offen lds
  v_mfma_f32_32x32x16_bf16 v[152:167], v[180:183], v[16:19], v[152:167]
  s_add_u32 m0, s46, 98304
  s_add_u32 s29, s47, 528384
  buffer_load_dwordx4 v232, s[4:7], s29 offen lds
  ds_read_b64_tr_b16 v[176:177], v237 offset:28800
  ds_read_b64_tr_b16 v[178:179], v237 offset:29568
  ds_read_b64_tr_b16 v[180:181], v237 offset:41088
  ds_read_b64_tr_b16 v[182:183], v237 offset:41856
  v_add_u32 v237, 57344, v237
  s_waitcnt lgkmcnt(8)
  v_mfma_f32_32x32x16_bf16 v[136:151], v[200:203], v[20:23], v[136:151]
  s_add_u32 m0, s46, 87040
  s_add_u32 s29, s47, 528384
  buffer_load_dwordx4 v233, s[16:19], s29 offen lds
  v_mfma_f32_32x32x16_bf16 v[152:167], v[204:207], v[20:23], v[152:167]
  s_add_u32 m0, s46, 99328
  s_add_u32 s29, s47, 528384
  buffer_load_dwordx4 v233, s[4:7], s29 offen lds
  ds_read_b64_tr_b16 v[200:201], v238 offset:28800
  ds_read_b64_tr_b16 v[202:203], v238 offset:29568
  ds_read_b64_tr_b16 v[204:205], v238 offset:41088
  ds_read_b64_tr_b16 v[206:207], v238 offset:41856
  v_add_u32 v238, 57344, v238
  s_waitcnt lgkmcnt(8)
  v_mfma_f32_32x32x16_bf16 v[136:151], v[208:211], v[24:27], v[136:151]
  s_add_u32 m0, s46, 88064
  s_add_u32 s29, s47, 528384
  buffer_load_dwordx4 v234, s[16:19], s29 offen lds
  v_mfma_f32_32x32x16_bf16 v[152:167], v[212:215], v[24:27], v[152:167]
  s_add_u32 m0, s46, 100352
  s_add_u32 s29, s47, 528384
  buffer_load_dwordx4 v234, s[4:7], s29 offen lds
  v_mfma_f32_16x16x32_bf16 v[216:219], v[184:187], v[208:211], v[216:219]
  ds_read_b64_tr_b16 v[208:209], v239 offset:28800
  ds_read_b64_tr_b16 v[210:211], v239 offset:29568
  ds_read_b64_tr_b16 v[212:213], v239 offset:41088
  ds_read_b64_tr_b16 v[214:215], v239 offset:41856
  v_add_u32 v239, 57344, v239
  s_waitcnt lgkmcnt(8)
  v_mfma_f32_32x32x16_bf16 v[136:151], v[176:179], v[28:31], v[136:151]
  v_mfma_f32_32x32x16_bf16 v[152:167], v[180:183], v[28:31], v[152:167]
  v_mfma_f32_16x16x32_bf16 v[220:223], v[184:187], v[180:183], v[220:223]
  s_waitcnt vmcnt(6)
  s_barrier
  ds_read_b64_tr_b16 v[176:177], v236 offset:128
  ds_read_b64_tr_b16 v[178:179], v236 offset:896
  ds_read_b64_tr_b16 v[180:181], v236 offset:12416
  ds_read_b64_tr_b16 v[182:183], v236 offset:13184
  s_waitcnt lgkmcnt(8)
  v_mfma_f32_32x32x16_bf16 v[136:151], v[200:203], v[32:35], v[136:151]
  s_add_u32 m0, s46, 0
  s_add_u32 s29, s47, 704512
  buffer_load_dwordx4 v232, s[16:19], s29 offen lds
  v_mfma_f32_32x32x16_bf16 v[152:167], v[204:207], v[32:35], v[152:167]
  s_add_u32 m0, s46, 12288
  s_add_u32 s29, s47, 704512
  buffer_load_dwordx4 v232, s[4:7], s29 offen lds
  ds_read_b64_tr_b16 v[200:201], v237 offset:128
  ds_read_b64_tr_b16 v[202:203], v237 offset:896
  ds_read_b64_tr_b16 v[204:205], v237 offset:12416
  ds_read_b64_tr_b16 v[206:207], v237 offset:13184
  s_waitcnt lgkmcnt(8)
  v_mfma_f32_32x32x16_bf16 v[136:151], v[208:211], v[36:39], v[136:151]
  s_add_u32 m0, s46, 1024
  s_add_u32 s29, s47, 704512
  buffer_load_dwordx4 v233, s[16:19], s29 offen lds
  v_mfma_f32_32x32x16_bf16 v[152:167], v[212:215], v[36:39], v[152:167]
  s_add_u32 m0, s46, 13312
  s_add_u32 s29, s47, 704512
  buffer_load_dwordx4 v233, s[4:7], s29 offen lds
  ds_read_b64_tr_b16 v[208:209], v238 offset:128
  ds_read_b64_tr_b16 v[210:211], v238 offset:896
  ds_read_b64_tr_b16 v[212:213], v238 offset:12416
  ds_read_b64_tr_b16 v[214:215], v238 offset:13184
  s_waitcnt lgkmcnt(8)
  v_mfma_f32_32x32x16_bf16 v[136:151], v[176:179], v[40:43], v[136:151]
  s_add_u32 m0, s46, 2048
  s_add_u32 s29, s47, 704512
  buffer_load_dwordx4 v234, s[16:19], s29 offen lds
  v_mfma_f32_32x32x16_bf16 v[152:167], v[180:183], v[40:43], v[152:167]
  s_add_u32 m0, s46, 14336
  s_add_u32 s29, s47, 704512
  buffer_load_dwordx4 v234, s[4:7], s29 offen lds
  v_mfma_f32_16x16x32_bf16 v[216:219], v[184:187], v[176:179], v[216:219]
  ds_read_b64_tr_b16 v[176:177], v239 offset:128
  ds_read_b64_tr_b16 v[178:179], v239 offset:896
  ds_read_b64_tr_b16 v[180:181], v239 offset:12416
  ds_read_b64_tr_b16 v[182:183], v239 offset:13184
  s_waitcnt lgkmcnt(8)
  v_mfma_f32_32x32x16_bf16 v[136:151], v[200:203], v[44:47], v[136:151]
  v_mfma_f32_32x32x16_bf16 v[152:167], v[204:207], v[44:47], v[152:167]
  v_mfma_f32_16x16x32_bf16 v[220:223], v[184:187], v[204:207], v[220:223]
  s_waitcnt vmcnt(6)
  s_barrier
  s_lshl_b32 s29, s27, 7
  s_lshl_b32 s30, s28, 2
  s_add_u32 s29, s29, s30
  s_add_u32 s29, s29, 14024704
  s_cmp_lg_u32 s24, 0
  s_cbranch_scc1 L_sig_13
  v_mov_b32 v5, s29
  v_mov_b32 v6, s3
  s_mov_b64 exec, 1
  global_store_dword v5, v6, s[20:21] sc1
  s_mov_b64 exec, -1
L_sig_13:
  ds_read_b64_tr_b16 v[200:201], v236 offset:28800
  ds_read_b64_tr_b16 v[202:203], v236 offset:29568
  ds_read_b64_tr_b16 v[204:205], v236 offset:41088
  ds_read_b64_tr_b16 v[206:207], v236 offset:41856
  v_subrev_u32 v236, 57344, v236
  s_waitcnt lgkmcnt(8)
  v_mfma_f32_32x32x16_bf16 v[136:151], v[208:211], v[48:51], v[136:151]
  s_add_u32 m0, s46, 28672
  s_add_u32 s29, s47, 880640
  buffer_load_dwordx4 v232, s[16:19], s29 offen lds
  v_mfma_f32_32x32x16_bf16 v[152:167], v[212:215], v[48:51], v[152:167]
  s_add_u32 m0, s46, 40960
  s_add_u32 s29, s47, 880640
  buffer_load_dwordx4 v232, s[4:7], s29 offen lds
  ds_read_b64_tr_b16 v[208:209], v237 offset:28800
  ds_read_b64_tr_b16 v[210:211], v237 offset:29568
  ds_read_b64_tr_b16 v[212:213], v237 offset:41088
  ds_read_b64_tr_b16 v[214:215], v237 offset:41856
  v_subrev_u32 v237, 57344, v237
  s_waitcnt lgkmcnt(8)
  v_mfma_f32_32x32x16_bf16 v[136:151], v[176:179], v[52:55], v[136:151]
  s_add_u32 m0, s46, 29696
  s_add_u32 s29, s47, 880640
  buffer_load_dwordx4 v233, s[16:19], s29 offen lds
  v_mfma_f32_32x32x16_bf16 v[152:167], v[180:183], v[52:55], v[152:167]
  s_add_u32 m0, s46, 41984
  s_add_u32 s29, s47, 880640
  buffer_load_dwordx4 v233, s[4:7], s29 offen lds
  ds_read_b64_tr_b16 v[176:177], v238 offset:28800
  ds_read_b64_tr_b16 v[178:179], v238 offset:29568
  ds_read_b64_tr_b16 v[180:181], v238 offset:41088
  ds_read_b64_tr_b16 v[182:183], v238 offset:41856
  v_subrev_u32 v238, 57344, v238
  s_waitcnt lgkmcnt(8)
  v_mfma_f32_32x32x16_bf16 v[136:151], v[200:203], v[56:59], v[136:151]
  s_add_u32 m0, s46, 30720
  s_add_u32 s29, s47, 880640
  buffer_load_dwordx4 v234, s[16:19], s29 offen lds
  v_mfma_f32_32x32x16_bf16 v[152:167], v[204:207], v[56:59], v[152:167]
  s_add_u32 m0, s46, 43008
  s_add_u32 s29, s47, 880640
  buffer_load_dwordx4 v234, s[4:7], s29 offen lds
  v_mfma_f32_16x16x32_bf16 v[216:219], v[184:187], v[200:203], v[216:219]
  ds_read_b64_tr_b16 v[200:201], v239 offset:28800
  ds_read_b64_tr_b16 v[202:203], v239 offset:29568
  ds_read_b64_tr_b16 v[204:205], v239 offset:41088
  ds_read_b64_tr_b16 v[206:207], v239 offset:41856
  v_subrev_u32 v239, 57344, v239
  s_waitcnt lgkmcnt(8)
  v_mfma_f32_32x32x16_bf16 v[136:151], v[208:211], v[60:63], v[136:151]
  v_mfma_f32_32x32x16_bf16 v[152:167], v[212:215], v[60:63], v[152:167]
  v_mfma_f32_16x16x32_bf16 v[220:223], v[184:187], v[212:215], v[220:223]
  s_waitcnt vmcnt(6)
  s_barrier
  ds_read_b64_tr_b16 v[208:209], v236 offset:128
  ds_read_b64_tr_b16 v[210:211], v236 offset:896
  ds_read_b64_tr_b16 v[212:213], v236 offset:12416
  ds_read_b64_tr_b16 v[214:215], v236 offset:13184
  s_waitcnt lgkmcnt(8)
  v_mfma_f32_32x32x16_bf16 v[136:151], v[176:179], v[64:67], v[136:151]
  s_add_u32 m0, s46, 57344
  s_add_u32 s29, s47, 1056768
  buffer_load_dwordx4 v232, s[16:19], s29 offen lds
  v_mfma_f32_32x32x16_bf16 v[152:167], v[180:183], v[64:67], v[152:167]
  s_add_u32 m0, s46, 69632
  s_add_u32 s29, s47, 1056768
  buffer_load_dwordx4 v232, s[4:7], s29 offen lds
  ds_read_b64_tr_b16 v[176:177], v237 offset:128
  ds_read_b64_tr_b16 v[178:179], v237 offset:896
  ds_read_b64_tr_b16 v[180:181], v237 offset:12416
  ds_read_b64_tr_b16 v[182:183], v237 offset:13184
  s_waitcnt lgkmcnt(8)
  v_mfma_f32_32x32x16_bf16 v[136:151], v[200:203], v[68:71], v[136:151]
  s_add_u32 m0, s46, 58368
  s_add_u32 s29, s47, 1056768
  buffer_load_dwordx4 v233, s[16:19], s29 offen lds
  v_mfma_f32_32x32x16_bf16 v[152:167], v[204:207], v[68:71], v[152:167]
  s_add_u32 m0, s46, 70656
  s_add_u32 s29, s47, 1056768
  buffer_load_dwordx4 v233, s[4:7], s29 offen lds
  ds_read_b64_tr_b16 v[200:201], v238 offset:128
  ds_read_b64_tr_b16 v[202:203], v238 offset:896
  ds_read_b64_tr_b16 v[204:205], v238 offset:12416
  ds_read_b64_tr_b16 v[206:207], v238 offset:13184
  s_waitcnt lgkmcnt(8)
  v_mfma_f32_32x32x16_bf16 v[136:151], v[208:211], v[72:75], v[136:151]
  s_add_u32 m0, s46, 59392
  s_add_u32 s29, s47, 1056768
  buffer_load_dwordx4 v234, s[16:19], s29 offen lds
  v_mfma_f32_32x32x16_bf16 v[152:167], v[212:215], v[72:75], v[152:167]
  s_add_u32 m0, s46, 71680
  s_add_u32 s29, s47, 1056768
  buffer_load_dwordx4 v234, s[4:7], s29 offen lds
  v_mfma_f32_16x16x32_bf16 v[216:219], v[184:187], v[208:211], v[216:219]
  ds_read_b64_tr_b16 v[208:209], v239 offset:128
  ds_read_b64_tr_b16 v[210:211], v239 offset:896
  ds_read_b64_tr_b16 v[212:213], v239 offset:12416
  ds_read_b64_tr_b16 v[214:215], v239 offset:13184
  s_waitcnt lgkmcnt(8)
  v_mfma_f32_32x32x16_bf16 v[136:151], v[176:179], v[76:79], v[136:151]
  v_mfma_f32_32x32x16_bf16 v[152:167], v[180:183], v[76:79], v[152:167]
  v_mfma_f32_16x16x32_bf16 v[220:223], v[184:187], v[180:183], v[220:223]
  s_waitcnt vmcnt(6)
  s_barrier
  ds_read_b64_tr_b16 v[176:177], v236 offset:28800
  ds_read_b64_tr_b16 v[178:179], v236 offset:29568
  ds_read_b64_tr_b16 v[180:181], v236 offset:41088
  ds_read_b64_tr_b16 v[182:183], v236 offset:41856
  v_add_u32 v236, 57344, v236
  s_waitcnt lgkmcnt(8)
  v_mfma_f32_32x32x16_bf16 v[136:151], v[200:203], v[80:83], v[136:151]
  s_add_u32 m0, s46, 86016
  s_add_u32 s29, s47, 1232896
  buffer_load_dwordx4 v232, s[16:19], s29 offen lds
  v_mfma_f32_32x32x16_bf16 v[152:167], v[204:207], v[80:83], v[152:167]
  s_add_u32 m0, s46, 98304
  s_add_u32 s29, s47, 1232896
  buffer_load_dwordx4 v232, s[4:7], s29 offen lds
  ds_read_b64_tr_b16 v[200:201], v237 offset:28800
  ds_read_b64_tr_b16 v[202:203], v237 offset:29568
  ds_read_b64_tr_b16 v[204:205], v237 offset:41088
  ds_read_b64_tr_b16 v[206:207], v237 offset:41856
  v_add_u32 v237, 57344, v237
  s_waitcnt lgkmcnt(8)
  v_mfma_f32_32x32x16_bf16 v[136:151], v[208:211], v[84:87], v[136:151]
  s_add_u32 m0, s46, 87040
  s_add_u32 s29, s47, 1232896
  buffer_load_dwordx4 v233, s[16:19], s29 offen lds
  v_mfma_f32_32x32x16_bf16 v[152:167], v[212:215], v[84:87], v[152:167]
  s_add_u32 m0, s46, 99328
  s_add_u32 s29, s47, 1232896
  buffer_load_dwordx4 v233, s[4:7], s29 offen lds
  ds_read_b64_tr_b16 v[208:209], v238 offset:28800
  ds_read_b64_tr_b16 v[210:211], v238 offset:29568
  ds_read_b64_tr_b16 v[212:213], v238 offset:41088
  ds_read_b64_tr_b16 v[214:215], v238 offset:41856
  v_add_u32 v238, 57344, v238
  s_waitcnt lgkmcnt(8)
  v_mfma_f32_32x32x16_bf16 v[136:151], v[176:179], v[88:91], v[136:151]
  s_add_u32 m0, s46, 88064
  s_add_u32 s29, s47, 1232896
  buffer_load_dwordx4 v234, s[16:19], s29 offen lds
  v_mfma_f32_32x32x16_bf16 v[152:167], v[180:183], v[88:91], v[152:167]
  s_add_u32 m0, s46, 100352
  s_add_u32 s29, s47, 1232896
  buffer_load_dwordx4 v234, s[4:7], s29 offen lds
  v_mfma_f32_16x16x32_bf16 v[216:219], v[184:187], v[176:179], v[216:219]
  ds_read_b64_tr_b16 v[176:177], v239 offset:28800
  ds_read_b64_tr_b16 v[178:179], v239 offset:29568
  ds_read_b64_tr_b16 v[180:181], v239 offset:41088
  ds_read_b64_tr_b16 v[182:183], v239 offset:41856
  v_add_u32 v239, 57344, v239
  s_waitcnt lgkmcnt(8)
  v_mfma_f32_32x32x16_bf16 v[136:151], v[200:203], v[92:95], v[136:151]
  v_mfma_f32_32x32x16_bf16 v[152:167], v[204:207], v[92:95], v[152:167]
  v_mfma_f32_16x16x32_bf16 v[220:223], v[184:187], v[204:207], v[220:223]
  s_waitcnt vmcnt(6)
  s_barrier
  ds_read_b64_tr_b16 v[200:201], v236 offset:128
  ds_read_b64_tr_b16 v[202:203], v236 offset:896
  ds_read_b64_tr_b16 v[204:205], v236 offset:12416
  ds_read_b64_tr_b16 v[206:207], v236 offset:13184
  s_waitcnt lgkmcnt(8)
  v_mfma_f32_32x32x16_bf16 v[136:151], v[208:211], v[96:99], v[136:151]
  v_mfma_f32_32x32x16_bf16 v[152:167], v[212:215], v[96:99], v[152:167]
  ds_read_b64_tr_b16 v[208:209], v237 offset:128
  ds_read_b64_tr_b16 v[210:211], v237 offset:896
  ds_read_b64_tr_b16 v[212:213], v237 offset:12416
  ds_read_b64_tr_b16 v[214:215], v237 offset:13184
  s_waitcnt lgkmcnt(8)
  v_mfma_f32_32x32x16_bf16 v[136:151], v[176:179], v[100:103], v[136:151]
  v_mfma_f32_32x32x16_bf16 v[152:167], v[180:183], v[100:103], v[152:167]
  ds_read_b64_tr_b16 v[176:177], v238 offset:128
  ds_read_b64_tr_b16 v[178:179], v238 offset:896
  ds_read_b64_tr_b16 v[180:181], v238 offset:12416
  ds_read_b64_tr_b16 v[182:183], v238 offset:13184
  s_waitcnt lgkmcnt(8)
  v_mfma_f32_32x32x16_bf16 v[136:151], v[200:203], v[104:107], v[136:151]
  v_mfma_f32_32x32x16_bf16 v[152:167], v[204:207], v[104:107], v[152:167]
  v_mfma_f32_16x16x32_bf16 v[216:219], v[184:187], v[200:203], v[216:219]
  ds_read_b64_tr_b16 v[200:201], v239 offset:128
  ds_read_b64_tr_b16 v[202:203], v239 offset:896
  ds_read_b64_tr_b16 v[204:205], v239 offset:12416
  ds_read_b64_tr_b16 v[206:207], v239 offset:13184
  s_waitcnt lgkmcnt(8)
  v_mfma_f32_32x32x16_bf16 v[136:151], v[208:211], v[108:111], v[136:151]
  v_mfma_f32_32x32x16_bf16 v[152:167], v[212:215], v[108:111], v[152:167]
  v_mfma_f32_16x16x32_bf16 v[220:223], v[184:187], v[212:215], v[220:223]
  s_waitcnt vmcnt(0)
  s_barrier
  ds_read_b64_tr_b16 v[208:209], v236 offset:28800
  ds_read_b64_tr_b16 v[210:211], v236 offset:29568
  ds_read_b64_tr_b16 v[212:213], v236 offset:41088
  ds_read_b64_tr_b16 v[214:215], v236 offset:41856
  v_subrev_u32 v236, 57344, v236
  s_waitcnt lgkmcnt(8)
  v_mfma_f32_32x32x16_bf16 v[136:151], v[176:179], v[112:115], v[136:151]
  v_mfma_f32_32x32x16_bf16 v[152:167], v[180:183], v[112:115], v[152:167]
  ds_read_b64_tr_b16 v[176:177], v237 offset:28800
  ds_read_b64_tr_b16 v[178:179], v237 offset:29568
  ds_read_b64_tr_b16 v[180:181], v237 offset:41088
  ds_read_b64_tr_b16 v[182:183], v237 offset:41856
  v_subrev_u32 v237, 57344, v237
  s_waitcnt lgkmcnt(8)
  v_mfma_f32_32x32x16_bf16 v[136:151], v[200:203], v[116:119], v[136:151]
  v_mfma_f32_32x32x16_bf16 v[152:167], v[204:207], v[116:119], v[152:167]
  ds_read_b64_tr_b16 v[200:201], v238 offset:28800
  ds_read_b64_tr_b16 v[202:203], v238 offset:29568
  ds_read_b64_tr_b16 v[204:205], v238 offset:41088
  ds_read_b64_tr_b16 v[206:207], v238 offset:41856
  v_subrev_u32 v238, 57344, v238
  s_waitcnt lgkmcnt(8)
  v_mfma_f32_32x32x16_bf16 v[136:151], v[208:211], v[120:123], v[136:151]
  v_mfma_f32_32x32x16_bf16 v[152:167], v[212:215], v[120:123], v[152:167]
  v_mfma_f32_16x16x32_bf16 v[216:219], v[184:187], v[208:211], v[216:219]
  ds_read_b64_tr_b16 v[208:209], v239 offset:28800
  ds_read_b64_tr_b16 v[210:211], v239 offset:29568
  ds_read_b64_tr_b16 v[212:213], v239 offset:41088
  ds_read_b64_tr_b16 v[214:215], v239 offset:41856
  v_subrev_u32 v239, 57344, v239
  s_waitcnt lgkmcnt(8)
  v_mfma_f32_32x32x16_bf16 v[136:151], v[176:179], v[124:127], v[136:151]
  v_mfma_f32_32x32x16_bf16 v[152:167], v[180:183], v[124:127], v[152:167]
  v_mfma_f32_16x16x32_bf16 v[220:223], v[184:187], v[180:183], v[220:223]
  s_waitcnt lgkmcnt(4)
  v_mfma_f32_32x32x16_bf16 v[136:151], v[200:203], v[128:131], v[136:151]
  v_mfma_f32_32x32x16_bf16 v[152:167], v[204:207], v[128:131], v[152:167]
  s_waitcnt lgkmcnt(0)
  v_mfma_f32_32x32x16_bf16 v[136:151], v[208:211], v[132:135], v[136:151]
  v_mfma_f32_32x32x16_bf16 v[152:167], v[212:215], v[132:135], v[152:167]
  s_nop 7
  v_lshlrev_b32 v1, 4, v0
  s_lshl_b32 s29, s25, 2
  s_add_u32 s29, s29, 134144
  v_add_u32 v1, s29, v1
  s_mov_b64 exec, 0xffff
  ds_write_b32 v1, v216 offset:0
  ds_write_b32 v1, v217 offset:256
  ds_write_b32 v1, v220 offset:512
  ds_write_b32 v1, v221 offset:768
  s_mov_b64 exec, -1
  s_waitcnt lgkmcnt(0)
  s_barrier
  s_lshl_b32 s33, s49, 16
  s_lshl_b32 s55, s50, 3
  s_lshl_b32 s29, s25, 1
  s_add_u32 s55, s55, s29
  s_lshl_b32 s29, s55, 10
  s_add_u32 s69, s33, s29
  s_lshl_b32 s33, s49, 16
  s_lshr_b32 s29, s24, 1
  s_and_b32 s29, s29, 1
  s_and_b32 s30, s24, 1
  s_lshl_b32 s30, s30, 2
  s_lshl_b32 s31, s26, 5
  s_add_u32 s30, s30, s31
  s_lshl_b32 s30, s30, 10
  s_lshl_b32 s31, s29, 16
  s_add_u32 s52, s31, s30
  s_lshl_b32 s31, s29, 21
  s_add_u32 s51, s31, s30
  s_add_u32 s51, s51, s33
  s_add_u32 s51, s51, 2097152
  s_add_u32 s51, s51, 16384
  s_add_u32 s52, s52, 16384
  s_and_b32 s29, s25, 1
  s_lshr_b32 s30, s25, 1
  s_lshl_b32 s30, s30, 15
  s_lshl_b32 s31, s29, 16
  s_add_u32 s67, s31, s30
  s_lshl_b32 s31, s29, 21
  s_add_u32 s68, s31, s30
  s_add_u32 s68, s68, s33
  s_add_u32 s68, s68, 2097152
  v_and_b32 v4, 31, v0
  v_lshlrev_b32 v4, 4, v4
  v_add_u32 v4, 132096, v4
  buffer_load_dwordx4 v[216:219], v255, s[20:23], s69 offen sc1
  buffer_load_dwordx4 v[220:223], v255, s[20:23], s69 offen offset:1024 sc1
  s_mov_b32 m0, s67
  s_add_u32 s67, s67, 4096
  buffer_load_dwordx4 v255, s[20:23], s68 offen offset:0 sc1 lds
  buffer_load_dwordx4 v255, s[20:23], s68 offen offset:1024 sc1 lds
  buffer_load_dwordx4 v255, s[20:23], s68 offen offset:2048 sc1 lds
  buffer_load_dwordx4 v255, s[20:23], s68 offen offset:3072 sc1 lds
  s_add_u32 s68, s68, 4096
  s_mov_b32 m0, s67
  s_add_u32 s67, s67, 4096
  buffer_load_dwordx4 v255, s[20:23], s68 offen offset:0 sc1 lds
  buffer_load_dwordx4 v255, s[20:23], s68 offen offset:1024 sc1 lds
  buffer_load_dwordx4 v255, s[20:23], s68 offen offset:2048 sc1 lds
  buffer_load_dwordx4 v255, s[20:23], s68 offen offset:3072 sc1 lds
  s_add_u32 s68, s68, 4096
  ds_read_b128 v[200:203], v4 offset:2048
  ds_read_b128 v[204:207], v4 offset:2560
  v_mov_b32 v9, 0
  v_mov_b32 v10, 0
  v_mov_b32 v11, 0
  v_mov_b32 v8, v251
  s_waitcnt lgkmcnt(1)
  v_add_f32 v200, v200, v201
  v_add_f32 v202, v202, v203
  v_mov_b32 v203, 0
  v_add_f32 v200, v200, v202
  v_cvt_pk_bf16_f32 v201, v200, v200
  v_lshlrev_b32 v201, 16, v201
  v_sub_f32 v202, v200, v201
  v_cvt_pk_bf16_f32 v200, v201, v202
  v_mov_b32 v201, 0
  v_mov_b32 v202, 0
  s_nop 1
  v_mfma_f32_32x32x16_bf16 v[136:151], v[200:203], v[8:11], v[136:151]
  s_waitcnt lgkmcnt(0)
  v_add_f32 v204, v204, v205
  v_add_f32 v206, v206, v207
  v_mov_b32 v207, 0
  v_add_f32 v204, v204, v206
  v_cvt_pk_bf16_f32 v205, v204, v204
  v_lshlrev_b32 v205, 16, v205
  v_sub_f32 v206, v204, v205
  v_cvt_pk_bf16_f32 v204, v205, v206
  v_mov_b32 v205, 0
  v_mov_b32 v206, 0
  s_nop 1
  v_mfma_f32_32x32x16_bf16 v[152:167], v[204:207], v[8:11], v[152:167]
  v_mul_f32 v12, 0xbfb8aa3b, v253
  v_mul_f32 v14, v252, v252
  s_nop 11
  v_pk_mul_f32 v[16:17], v[136:137], v[12:13] op_sel_hi:[1,0]
  v_pk_mul_f32 v[18:19], v[138:139], v[12:13] op_sel_hi:[1,0]
  v_pk_mul_f32 v[20:21], v[140:141], v[12:13] op_sel_hi:[1,0]
  v_pk_mul_f32 v[22:23], v[142:143], v[12:13] op_sel_hi:[1,0]
  v_pk_mul_f32 v[24:25], v[144:145], v[12:13] op_sel_hi:[1,0]
  v_pk_mul_f32 v[26:27], v[146:147], v[12:13] op_sel_hi:[1,0]
  v_pk_mul_f32 v[28:29], v[148:149], v[12:13] op_sel_hi:[1,0]
  v_pk_mul_f32 v[30:31], v[150:151], v[12:13] op_sel_hi:[1,0]
  v_exp_f32 v16, v16
  v_exp_f32 v17, v17
  v_exp_f32 v18, v18
  v_exp_f32 v19, v19
  v_exp_f32 v20, v20
  v_exp_f32 v21, v21
  v_exp_f32 v22, v22
  v_exp_f32 v23, v23
  v_exp_f32 v24, v24
  v_exp_f32 v25, v25
  v_exp_f32 v26, v26
  v_exp_f32 v27, v27
  v_exp_f32 v28, v28
  v_exp_f32 v29, v29
  v_exp_f32 v30, v30
  v_exp_f32 v31, v31
  v_pk_mul_f32 v[136:137], v[136:137], v[152:153]
  v_pk_mul_f32 v[138:139], v[138:139], v[154:155]
  v_pk_mul_f32 v[140:141], v[140:141], v[156:157]
  v_pk_mul_f32 v[142:143], v[142:143], v[158:159]
  v_pk_mul_f32 v[144:145], v[144:145], v[160:161]
  v_pk_mul_f32 v[146:147], v[146:147], v[162:163]
  v_pk_mul_f32 v[148:149], v[148:149], v[164:165]
  v_pk_mul_f32 v[150:151], v[150:151], v[166:167]
  v_pk_fma_f32 v[16:17], v[16:17], v[14:15], v[14:15] op_sel_hi:[1,0,0]
  v_pk_fma_f32 v[18:19], v[18:19], v[14:15], v[14:15] op_sel_hi:[1,0,0]
  v_pk_fma_f32 v[20:21], v[20:21], v[14:15], v[14:15] op_sel_hi:[1,0,0]
  v_pk_fma_f32 v[22:23], v[22:23], v[14:15], v[14:15] op_sel_hi:[1,0,0]
  v_pk_fma_f32 v[24:25], v[24:25], v[14:15], v[14:15] op_sel_hi:[1,0,0]
  v_pk_fma_f32 v[26:27], v[26:27], v[14:15], v[14:15] op_sel_hi:[1,0,0]
  v_pk_fma_f32 v[28:29], v[28:29], v[14:15], v[14:15] op_sel_hi:[1,0,0]
  v_pk_fma_f32 v[30:31], v[30:31], v[14:15], v[14:15] op_sel_hi:[1,0,0]
  v_rcp_f32 v16, v16
  v_rcp_f32 v17, v17
  v_rcp_f32 v18, v18
  v_rcp_f32 v19, v19
  v_rcp_f32 v20, v20
  v_rcp_f32 v21, v21
  v_rcp_f32 v22, v22
  v_rcp_f32 v23, v23
  v_rcp_f32 v24, v24
  v_rcp_f32 v25, v25
  v_rcp_f32 v26, v26
  v_rcp_f32 v27, v27
  v_rcp_f32 v28, v28
  v_rcp_f32 v29, v29
  v_rcp_f32 v30, v30
  v_rcp_f32 v31, v31
  s_nop 0
  v_pk_mul_f32 v[136:137], v[136:137], v[16:17]
  v_pk_mul_f32 v[138:139], v[138:139], v[18:19]
  v_pk_mul_f32 v[140:141], v[140:141], v[20:21]
  v_pk_mul_f32 v[142:143], v[142:143], v[22:23]
  v_pk_mul_f32 v[144:145], v[144:145], v[24:25]
  v_pk_mul_f32 v[146:147], v[146:147], v[26:27]
  v_pk_mul_f32 v[148:149], v[148:149], v[28:29]
  v_pk_mul_f32 v[150:151], v[150:151], v[30:31]
  v_cvt_pk_bf16_f32 v32, v136, v137
  v_cvt_pk_bf16_f32 v33, v138, v139
  v_cvt_pk_bf16_f32 v34, v140, v141
  v_cvt_pk_bf16_f32 v35, v142, v143
  v_cvt_pk_bf16_f32 v36, v144, v145
  v_cvt_pk_bf16_f32 v37, v146, v147
  v_cvt_pk_bf16_f32 v38, v148, v149
  v_cvt_pk_bf16_f32 v39, v150, v151
  s_mul_i32 s29, s27, 3
  s_add_u32 s29, s29, 2
  s_mul_i32 s30, s48, 86
  s_lshl_b32 s31, s29, 1
  s_add_u32 s30, s30, s31
  s_lshl_b32 s30, s30, 10
  s_add_u32 s30, s30, 6291456
  s_cmp_ge_u32 s29, 43
  s_cselect_b32 s30, 14024704, s30
  buffer_store_dwordx4 v[32:35], v255, s[20:23], s30 offen sc1
  buffer_store_dwordx4 v[36:39], v255, s[20:23], s30 offen offset:1024 sc1
L_join:
  s_nop 1
  v_mov_b32 v4, 0xdddddddd
  v_and_b32 v5, 27, v0
  v_cmp_eq_u32 vcc, 16, v5
  v_mov_b32 v6, 0x3f803f80
  s_mov_b32 s56, 0x0000ffff
  v_cndmask_b32 v24, 0, v6, vcc
  v_mov_b32 v25, v24
  v_mov_b64 v[26:27], v[24:25]
  v_mov_b64 v[28:29], v[24:25]
  v_mov_b64 v[30:31], v[24:25]
  v_mov_b64 v[32:33], v[24:25]
  v_mov_b64 v[34:35], v[24:25]
  v_mov_b64 v[36:37], v[24:25]
  v_mov_b64 v[38:39], v[24:25]
  s_mov_b32 s57, 0x0000ffff
  s_mov_b32 s54, 0
  s_lshl_b32 s35, s26, 15
  v_lshrrev_b32 v5, 5, v0
  v_lshlrev_b32 v5, 8, v5
  v_and_b32 v6, 15, v0
  v_lshl_add_u32 v5, v6, 4, v5
  s_add_u32 s29, s35, 65536
  v_add_u32 v1, s29, v5
  v_mov_b32 v5, 151552
  v_mov_b32 v6, 0
  ds_write_b32 v5, v6
  v_mov_b64 v[72:73], 0
  v_mov_b64 v[74:75], 0
  v_mov_b64 v[76:77], 0
  v_mov_b64 v[78:79], 0
  v_mov_b64 v[80:81], 0
  v_mov_b64 v[82:83], 0
  v_mov_b64 v[84:85], 0
  v_mov_b64 v[86:87], 0
  v_mov_b64 v[88:89], 0
  v_mov_b64 v[90:91], 0
  v_mov_b64 v[92:93], 0
  v_mov_b64 v[94:95], 0
  v_mov_b64 v[96:97], 0
  v_mov_b64 v[98:99], 0
  v_mov_b64 v[100:101], 0
  v_mov_b64 v[102:103], 0
  s_waitcnt vmcnt(4) lgkmcnt(0)
  s_cmp_eq_u32 s26, 0
  s_cbranch_scc1 L_bw0
  s_waitcnt vmcnt(2)
L_bw0:
  s_barrier
L_redo:
  s_cmp_eq_u32 s54, 0
  s_cselect_b32 s29, 1, 32
  v_add_u32 v2, s35, v255
  v_mov_b32 v136, 0xff800000
  v_mov_b32 v137, 0xff800000
L_maxloop:
  ds_read_b128 v[16:19], v2
  v_add_u32 v2, 1024, v2
  s_waitcnt lgkmcnt(0)
  v_mfma_f32_32x32x16_bf16 v[40:55], v[16:19], v[216:219], 0
  v_mfma_f32_32x32x16_bf16 v[56:71], v[16:19], v[220:223], 0
  s_sub_u32 s29, s29, 1
  s_nop 11
  v_max3_f32 v136, v136, v40, v41
  v_max3_f32 v137, v137, v56, v57
  v_max3_f32 v136, v136, v42, v43
  v_max3_f32 v137, v137, v58, v59
  v_max3_f32 v136, v136, v44, v45
  v_max3_f32 v137, v137, v60, v61
  v_max3_f32 v136, v136, v46, v47
  v_max3_f32 v137, v137, v62, v63
  v_max3_f32 v136, v136, v48, v49
  v_max3_f32 v137, v137, v64, v65
  v_max3_f32 v136, v136, v50, v51
  v_max3_f32 v137, v137, v66, v67
  v_max3_f32 v136, v136, v52, v53
  v_max3_f32 v137, v137, v68, v69
  v_max3_f32 v136, v136, v54, v55
  v_max3_f32 v137, v137, v70, v71
  s_cmp_lg_u32 s29, 0
  s_cbranch_scc1 L_maxloop
  v_mov_b32 v138, v136
  v_mov_b32 v139, v137
  v_add_u32 v2, s35, v255
  v_mov_b32 v3, v1
  v_permlane32_swap_b32 v136, v138
  v_permlane32_swap_b32 v137, v139
  s_mov_b64 exec, s[56:57]
  ds_read_b128 v[24:27], v3
  ds_read_b128 v[28:31], v3 offset:512
  s_mov_b64 exec, -1
  v_max_f32 v136, v136, v138
  v_max_f32 v137, v137, v139
  ds_read_b128 v[16:19], v2
  v_sub_f32 v104, 0, v136
  v_sub_f32 v105, 0, v136
  v_sub_f32 v106, 0, v136
  v_sub_f32 v107, 0, v136
  v_sub_f32 v108, 0, v136
  v_sub_f32 v109, 0, v136
  v_sub_f32 v110, 0, v136
  v_sub_f32 v111, 0, v136
  v_sub_f32 v112, 0, v136
  v_sub_f32 v113, 0, v136
  v_sub_f32 v114, 0, v136
  v_sub_f32 v115, 0, v136
  v_sub_f32 v116, 0, v136
  v_sub_f32 v117, 0, v136
  v_sub_f32 v118, 0, v136
  v_sub_f32 v119, 0, v136
  s_waitcnt lgkmcnt(0)
  s_nop 0
  v_mfma_f32_32x32x16_bf16 v[40:55], v[16:19], v[216:219], v[104:119]
  v_sub_f32 v120, 0, v137
  v_sub_f32 v121, 0, v137
  v_sub_f32 v122, 0, v137
  v_sub_f32 v123, 0, v137
  v_sub_f32 v124, 0, v137
  v_sub_f32 v125, 0, v137
  v_sub_f32 v126, 0, v137
  v_sub_f32 v127, 0, v137
  v_sub_f32 v128, 0, v137
  v_sub_f32 v129, 0, v137
  v_sub_f32 v130, 0, v137
  v_sub_f32 v131, 0, v137
  v_sub_f32 v132, 0, v137
  v_sub_f32 v133, 0, v137
  v_sub_f32 v134, 0, v137
  v_sub_f32 v135, 0, v137
  v_mov_b32 v64, 0
  v_mov_b32 v65, 0
  v_mov_b32 v66, 0
  v_mov_b32 v67, 0
  v_mov_b32 v68, 0
  v_mov_b32 v69, 0
  v_mov_b32 v70, 0
  v_mov_b32 v71, 0
  s_cmp_lg_u32 s54, 0
  s_cbranch_scc1 L_rloop0
  s_cmp_lg_u32 s26, 1
  s_cbranch_scc1 L_prio_14
  s_setprio 3
L_prio_14:
  s_cmp_eq_u32 s26, 0
  s_cbranch_scc1 L_kv1
  s_mov_b32 m0, s67
  s_add_u32 s67, s67, 4096
  buffer_load_dwordx4 v255, s[20:23], s68 offen offset:0 sc1 lds
  buffer_load_dwordx4 v255, s[20:23], s68 offen offset:1024 sc1 lds
  buffer_load_dwordx4 v255, s[20:23], s68 offen offset:2048 sc1 lds
  buffer_load_dwordx4 v255, s[20:23], s68 offen offset:3072 sc1 lds
  s_add_u32 s68, s68, 4096
  s_mov_b32 m0, s67
  s_add_u32 s67, s67, 4096
  buffer_load_dwordx4 v255, s[20:23], s68 offen offset:0 sc1 lds
  buffer_load_dwordx4 v255, s[20:23], s68 offen offset:1024 sc1 lds
  buffer_load_dwordx4 v255, s[20:23], s68 offen offset:2048 sc1 lds
  buffer_load_dwordx4 v255, s[20:23], s68 offen offset:3072 sc1 lds
  s_add_u32 s68, s68, 4096
L_kv1:
  v_exp_f32 v40, v40
  v_exp_f32 v41, v41
  v_exp_f32 v42, v42
  v_smfmac_f32_32x32x32_bf16 v[88:103], v[36:39], v[64:71], v4
  v_exp_f32 v43, v43
  v_exp_f32 v44, v44
  v_mfma_f32_32x32x16_bf16 v[56:71], v[16:19], v[220:223], v[120:135]
  v_exp_f32 v45, v45
  v_exp_f32 v46, v46
  v_exp_f32 v47, v47
  ds_read_b128 v[20:23], v2 offset:1024
  s_mov_b64 exec, s[56:57]
  ds_read_b128 v[32:35], v3 offset:1024
  ds_read_b128 v[36:39], v3 offset:1536
  s_mov_b64 exec, -1
  v_exp_f32 v48, v48
  v_exp_f32 v49, v49
  v_exp_f32 v50, v50
  v_smfmac_f32_32x32x32_bf16 v[72:87], v[24:27], v[40:47], v4
  v_exp_f32 v51, v51
  v_exp_f32 v52, v52
  v_exp_f32 v53, v53
  v_exp_f32 v54, v54
  v_exp_f32 v55, v55
  v_exp_f32 v56, v56
  v_exp_f32 v57, v57
  v_exp_f32 v58, v58
  v_smfmac_f32_32x32x32_bf16 v[72:87], v[28:31], v[48:55], v4
  v_exp_f32 v59, v59
  v_exp_f32 v60, v60
  s_waitcnt lgkmcnt(0)
  v_mfma_f32_32x32x16_bf16 v[40:55], v[20:23], v[216:219], v[104:119]
  v_exp_f32 v61, v61
  v_exp_f32 v62, v62
  v_exp_f32 v63, v63
  v_exp_f32 v64, v64
  v_exp_f32 v65, v65
  v_exp_f32 v66, v66
  v_smfmac_f32_32x32x32_bf16 v[88:103], v[24:27], v[56:63], v4
  v_exp_f32 v67, v67
  v_exp_f32 v68, v68
  v_exp_f32 v69, v69
  v_exp_f32 v70, v70
  v_exp_f32 v71, v71
  v_exp_f32 v40, v40
  v_exp_f32 v41, v41
  v_exp_f32 v42, v42
  v_smfmac_f32_32x32x32_bf16 v[88:103], v[28:31], v[64:71], v4
  v_exp_f32 v43, v43
  v_exp_f32 v44, v44
  v_mfma_f32_32x32x16_bf16 v[56:71], v[20:23], v[220:223], v[120:135]
  v_exp_f32 v45, v45
  v_exp_f32 v46, v46
  v_exp_f32 v47, v47
  ds_read_b128 v[16:19], v2 offset:2048
  s_mov_b64 exec, s[56:57]
  ds_read_b128 v[24:27], v3 offset:2048
  ds_read_b128 v[28:31], v3 offset:2560
  s_mov_b64 exec, -1
  v_exp_f32 v48, v48
  v_exp_f32 v49, v49
  v_exp_f32 v50, v50
  v_smfmac_f32_32x32x32_bf16 v[72:87], v[32:35], v[40:47], v4
  v_exp_f32 v51, v51
  v_exp_f32 v52, v52
  v_exp_f32 v53, v53
  v_exp_f32 v54, v54
  v_exp_f32 v55, v55
  v_exp_f32 v56, v56
  v_exp_f32 v57, v57
  v_exp_f32 v58, v58
  v_smfmac_f32_32x32x32_bf16 v[72:87], v[36:39], v[48:55], v4
  v_exp_f32 v59, v59
  v_exp_f32 v60, v60
  s_waitcnt lgkmcnt(0)
  v_mfma_f32_32x32x16_bf16 v[40:55], v[16:19], v[216:219], v[104:119]
  v_exp_f32 v61, v61
  v_exp_f32 v62, v62
  v_exp_f32 v63, v63
  v_exp_f32 v64, v64
  v_exp_f32 v65, v65
  v_exp_f32 v66, v66
  v_smfmac_f32_32x32x32_bf16 v[88:103], v[32:35], v[56:63], v4
  v_exp_f32 v67, v67
  v_exp_f32 v68, v68
  v_exp_f32 v69, v69
  v_exp_f32 v70, v70
  v_exp_f32 v71, v71
  s_mov_b32 m0, s52
  s_add_u32 s52, s52, 8192
  buffer_load_dwordx4 v255, s[20:23], s51 offen offset:0 sc1 lds
  buffer_load_dwordx4 v255, s[20:23], s51 offen offset:1024 sc1 lds
  buffer_load_dwordx4 v255, s[20:23], s51 offen offset:2048 sc1 lds
  buffer_load_dwordx4 v255, s[20:23], s51 offen offset:3072 sc1 lds
  s_add_u32 s51, s51, 8192
  v_exp_f32 v40, v40
  v_exp_f32 v41, v41
  v_exp_f32 v42, v42
  v_smfmac_f32_32x32x32_bf16 v[88:103], v[36:39], v[64:71], v4
  v_exp_f32 v43, v43
  v_exp_f32 v44, v44
  v_mfma_f32_32x32x16_bf16 v[56:71], v[16:19], v[220:223], v[120:135]
  v_exp_f32 v45, v45
  v_exp_f32 v46, v46
  v_exp_f32 v47, v47
  ds_read_b128 v[20:23], v2 offset:3072
  s_mov_b64 exec, s[56:57]
  ds_read_b128 v[32:35], v3 offset:3072
  ds_read_b128 v[36:39], v3 offset:3584
  s_mov_b64 exec, -1
  v_exp_f32 v48, v48
  v_exp_f32 v49, v49
  v_exp_f32 v50, v50
  v_smfmac_f32_32x32x32_bf16 v[72:87], v[24:27], v[40:47], v4
  v_exp_f32 v51, v51
  v_exp_f32 v52, v52
  v_exp_f32 v53, v53
  v_exp_f32 v54, v54
  v_exp_f32 v55, v55
  v_exp_f32 v56, v56
  v_exp_f32 v57, v57
  v_exp_f32 v58, v58
  v_smfmac_f32_32x32x32_bf16 v[72:87], v[28:31], v[48:55], v4
  v_exp_f32 v59, v59
  v_exp_f32 v60, v60
  s_waitcnt lgkmcnt(0)
  v_mfma_f32_32x32x16_bf16 v[40:55], v[20:23], v[216:219], v[104:119]
  v_exp_f32 v61, v61
  v_exp_f32 v62, v62
  v_exp_f32 v63, v63
  v_exp_f32 v64, v64
  v_exp_f32 v65, v65
  v_exp_f32 v66, v66
  v_smfmac_f32_32x32x32_bf16 v[88:103], v[24:27], v[56:63], v4
  v_exp_f32 v67, v67
  v_exp_f32 v68, v68
  v_exp_f32 v69, v69
  v_exp_f32 v70, v70
  v_exp_f32 v71, v71
  v_exp_f32 v40, v40
  v_exp_f32 v41, v41
  v_exp_f32 v42, v42
  v_smfmac_f32_32x32x32_bf16 v[88:103], v[28:31], v[64:71], v4
  v_exp_f32 v43, v43
  v_exp_f32 v44, v44
  v_mfma_f32_32x32x16_bf16 v[56:71], v[20:23], v[220:223], v[120:135]
  v_exp_f32 v45, v45
  v_exp_f32 v46, v46
  v_exp_f32 v47, v47
  ds_read_b128 v[16:19], v2 offset:4096
  s_mov_b64 exec, s[56:57]
  ds_read_b128 v[24:27], v3 offset:4096
  ds_read_b128 v[28:31], v3 offset:4608
  s_mov_b64 exec, -1
  v_exp_f32 v48, v48
  v_exp_f32 v49, v49
  v_exp_f32 v50, v50
  v_smfmac_f32_32x32x32_bf16 v[72:87], v[32:35], v[40:47], v4
  v_exp_f32 v51, v51
  v_exp_f32 v52, v52
  v_exp_f32 v53, v53
  v_exp_f32 v54, v54
  v_exp_f32 v55, v55
  v_exp_f32 v56, v56
  v_exp_f32 v57, v57
  v_exp_f32 v58, v58
  v_smfmac_f32_32x32x32_bf16 v[72:87], v[36:39], v[48:55], v4
  v_exp_f32 v59, v59
  v_exp_f32 v60, v60
  s_waitcnt lgkmcnt(0)
  v_mfma_f32_32x32x16_bf16 v[40:55], v[16:19], v[216:219], v[104:119]
  v_exp_f32 v61, v61
  v_exp_f32 v62, v62
  v_exp_f32 v63, v63
  v_exp_f32 v64, v64
  v_exp_f32 v65, v65
  v_exp_f32 v66, v66
  v_smfmac_f32_32x32x32_bf16 v[88:103], v[32:35], v[56:63], v4
  v_exp_f32 v67, v67
  v_exp_f32 v68, v68
  v_exp_f32 v69, v69
  v_exp_f32 v70, v70
  v_exp_f32 v71, v71
  s_mov_b32 m0, s52
  s_add_u32 s52, s52, 8192
  buffer_load_dwordx4 v255, s[20:23], s51 offen offset:0 sc1 lds
  buffer_load_dwordx4 v255, s[20:23], s51 offen offset:1024 sc1 lds
  buffer_load_dwordx4 v255, s[20:23], s51 offen offset:2048 sc1 lds
  buffer_load_dwordx4 v255, s[20:23], s51 offen offset:3072 sc1 lds
  s_add_u32 s51, s51, 8192
  v_exp_f32 v40, v40
  v_exp_f32 v41, v41
  v_exp_f32 v42, v42
  v_smfmac_f32_32x32x32_bf16 v[88:103], v[36:39], v[64:71], v4
  v_exp_f32 v43, v43
  v_exp_f32 v44, v44
  v_mfma_f32_32x32x16_bf16 v[56:71], v[16:19], v[220:223], v[120:135]
  v_exp_f32 v45, v45
  v_exp_f32 v46, v46
  v_exp_f32 v47, v47
  ds_read_b128 v[20:23], v2 offset:5120
  s_mov_b64 exec, s[56:57]
  ds_read_b128 v[32:35], v3 offset:5120
  ds_read_b128 v[36:39], v3 offset:5632
  s_mov_b64 exec, -1
  v_exp_f32 v48, v48
  v_exp_f32 v49, v49
  v_exp_f32 v50, v50
  v_smfmac_f32_32x32x32_bf16 v[72:87], v[24:27], v[40:47], v4
  v_exp_f32 v51, v51
  v_exp_f32 v52, v52
  v_exp_f32 v53, v53
  v_exp_f32 v54, v54
  v_exp_f32 v55, v55
  v_exp_f32 v56, v56
  v_exp_f32 v57, v57
  v_exp_f32 v58, v58
  v_smfmac_f32_32x32x32_bf16 v[72:87], v[28:31], v[48:55], v4
  v_exp_f32 v59, v59
  v_exp_f32 v60, v60
  s_waitcnt lgkmcnt(0)
  v_mfma_f32_32x32x16_bf16 v[40:55], v[20:23], v[216:219], v[104:119]
  v_exp_f32 v61, v61
  v_exp_f32 v62, v62
  v_exp_f32 v63, v63
  v_exp_f32 v64, v64
  v_exp_f32 v65, v65
  v_exp_f32 v66, v66
  v_smfmac_f32_32x32x32_bf16 v[88:103], v[24:27], v[56:63], v4
  v_exp_f32 v67, v67
  v_exp_f32 v68, v68
  v_exp_f32 v69, v69
  v_exp_f32 v70, v70
  v_exp_f32 v71, v71
  v_exp_f32 v40, v40
  v_exp_f32 v41, v41
  v_exp_f32 v42, v42
  v_smfmac_f32_32x32x32_bf16 v[88:103], v[28:31], v[64:71], v4
  v_exp_f32 v43, v43
  v_exp_f32 v44, v44
  v_mfma_f32_32x32x16_bf16 v[56:71], v[20:23], v[220:223], v[120:135]
  v_exp_f32 v45, v45
  v_exp_f32 v46, v46
  v_exp_f32 v47, v47
  ds_read_b128 v[16:19], v2 offset:6144
  s_mov_b64 exec, s[56:57]
  ds_read_b128 v[24:27], v3 offset:6144
  ds_read_b128 v[28:31], v3 offset:6656
  s_mov_b64 exec, -1
  v_exp_f32 v48, v48
  v_exp_f32 v49, v49
  v_exp_f32 v50, v50
  v_smfmac_f32_32x32x32_bf16 v[72:87], v[32:35], v[40:47], v4
  v_exp_f32 v51, v51
  v_exp_f32 v52, v52
  v_exp_f32 v53, v53
  v_exp_f32 v54, v54
  v_exp_f32 v55, v55
  v_exp_f32 v56, v56
  v_exp_f32 v57, v57
  v_exp_f32 v58, v58
  v_smfmac_f32_32x32x32_bf16 v[72:87], v[36:39], v[48:55], v4
  v_exp_f32 v59, v59
  v_exp_f32 v60, v60
  s_waitcnt lgkmcnt(0)
  v_mfma_f32_32x32x16_bf16 v[40:55], v[16:19], v[216:219], v[104:119]
  v_exp_f32 v61, v61
  v_exp_f32 v62, v62
  v_exp_f32 v63, v63
  v_exp_f32 v64, v64
  v_exp_f32 v65, v65
  v_exp_f32 v66, v66
  v_smfmac_f32_32x32x32_bf16 v[88:103], v[32:35], v[56:63], v4
  v_exp_f32 v67, v67
  v_exp_f32 v68, v68
  v_exp_f32 v69, v69
  v_exp_f32 v70, v70
  v_exp_f32 v71, v71
  s_waitcnt vmcnt(8)
  s_barrier
  s_lshl_b32 s29, s28, 7
  s_lshl_b32 s30, s27, 2
  s_add_u32 s29, s29, s30
  s_add_u32 s29, s29, 14028800
  s_cmp_lg_u32 s24, 0
  s_cbranch_scc1 L_sig_15
  v_mov_b32 v5, s29
  v_mov_b32 v6, s3
  s_mov_b64 exec, 1
  global_store_dword v5, v6, s[20:21] sc1
  s_mov_b64 exec, -1
L_sig_15:
  s_lshr_b32 s29, s58, 1
  s_lshl_b32 s29, s29, 7
  s_add_u32 s29, s29, 14028800
  v_and_b32 v7, 15, v0
  v_lshl_add_u32 v7, v7, 2, s29
  v_exp_f32 v40, v40
  v_exp_f32 v41, v41
  v_exp_f32 v42, v42
  v_smfmac_f32_32x32x32_bf16 v[88:103], v[36:39], v[64:71], v4
  v_exp_f32 v43, v43
  v_exp_f32 v44, v44
  v_mfma_f32_32x32x16_bf16 v[56:71], v[16:19], v[220:223], v[120:135]
  v_exp_f32 v45, v45
  v_exp_f32 v46, v46
  v_exp_f32 v47, v47
  ds_read_b128 v[20:23], v2 offset:7168
  s_mov_b64 exec, s[56:57]
  ds_read_b128 v[32:35], v3 offset:7168
  ds_read_b128 v[36:39], v3 offset:7680
  s_mov_b64 exec, -1
  v_exp_f32 v48, v48
  v_exp_f32 v49, v49
  v_exp_f32 v50, v50
  v_smfmac_f32_32x32x32_bf16 v[72:87], v[24:27], v[40:47], v4
  v_exp_f32 v51, v51
  v_exp_f32 v52, v52
  v_exp_f32 v53, v53
  v_exp_f32 v54, v54
  v_exp_f32 v55, v55
  v_exp_f32 v56, v56
  v_exp_f32 v57, v57
  v_exp_f32 v58, v58
  v_smfmac_f32_32x32x32_bf16 v[72:87], v[28:31], v[48:55], v4
  v_exp_f32 v59, v59
  v_exp_f32 v60, v60
  s_waitcnt lgkmcnt(0)
  v_mfma_f32_32x32x16_bf16 v[40:55], v[20:23], v[216:219], v[104:119]
  v_exp_f32 v61, v61
  v_exp_f32 v62, v62
  v_exp_f32 v63, v63
  v_exp_f32 v64, v64
  v_exp_f32 v65, v65
  v_exp_f32 v66, v66
  v_smfmac_f32_32x32x32_bf16 v[88:103], v[24:27], v[56:63], v4
  v_exp_f32 v67, v67
  v_exp_f32 v68, v68
  v_exp_f32 v69, v69
  v_exp_f32 v70, v70
  v_exp_f32 v71, v71
  v_exp_f32 v40, v40
  v_exp_f32 v41, v41
  v_exp_f32 v42, v42
  v_smfmac_f32_32x32x32_bf16 v[88:103], v[28:31], v[64:71], v4
  v_exp_f32 v43, v43
  v_exp_f32 v44, v44
  v_mfma_f32_32x32x16_bf16 v[56:71], v[20:23], v[220:223], v[120:135]
  v_exp_f32 v45, v45
  v_exp_f32 v46, v46
  v_exp_f32 v47, v47
  ds_read_b128 v[16:19], v2 offset:8192
  s_mov_b64 exec, s[56:57]
  ds_read_b128 v[24:27], v3 offset:8192
  ds_read_b128 v[28:31], v3 offset:8704
  s_mov_b64 exec, -1
  v_exp_f32 v48, v48
  v_exp_f32 v49, v49
  v_exp_f32 v50, v50
  v_smfmac_f32_32x32x32_bf16 v[72:87], v[32:35], v[40:47], v4
  v_exp_f32 v51, v51
  v_exp_f32 v52, v52
  v_exp_f32 v53, v53
  v_exp_f32 v54, v54
  v_exp_f32 v55, v55
  v_exp_f32 v56, v56
  v_exp_f32 v57, v57
  v_exp_f32 v58, v58
  v_smfmac_f32_32x32x32_bf16 v[72:87], v[36:39], v[48:55], v4
  v_exp_f32 v59, v59
  v_exp_f32 v60, v60
  s_waitcnt lgkmcnt(0)
  v_mfma_f32_32x32x16_bf16 v[40:55], v[16:19], v[216:219], v[104:119]
  v_exp_f32 v61, v61
  v_exp_f32 v62, v62
  v_exp_f32 v63, v63
  v_exp_f32 v64, v64
  v_exp_f32 v65, v65
  v_exp_f32 v66, v66
  v_smfmac_f32_32x32x32_bf16 v[88:103], v[32:35], v[56:63], v4
  v_exp_f32 v67, v67
  v_exp_f32 v68, v68
  v_exp_f32 v69, v69
  v_exp_f32 v70, v70
  v_exp_f32 v71, v71
  v_exp_f32 v40, v40
  v_exp_f32 v41, v41
  v_exp_f32 v42, v42
  v_smfmac_f32_32x32x32_bf16 v[88:103], v[36:39], v[64:71], v4
  v_exp_f32 v43, v43
  v_exp_f32 v44, v44
  v_mfma_f32_32x32x16_bf16 v[56:71], v[16:19], v[220:223], v[120:135]
  v_exp_f32 v45, v45
  v_exp_f32 v46, v46
  v_exp_f32 v47, v47
  ds_read_b128 v[20:23], v2 offset:9216
  s_mov_b64 exec, s[56:57]
  ds_read_b128 v[32:35], v3 offset:9216
  ds_read_b128 v[36:39], v3 offset:9728
  s_mov_b64 exec, -1
  v_exp_f32 v48, v48
  v_exp_f32 v49, v49
  v_exp_f32 v50, v50
  v_smfmac_f32_32x32x32_bf16 v[72:87], v[24:27], v[40:47], v4
  v_exp_f32 v51, v51
  v_exp_f32 v52, v52
  v_exp_f32 v53, v53
  v_exp_f32 v54, v54
  v_exp_f32 v55, v55
  v_exp_f32 v56, v56
  v_exp_f32 v57, v57
  v_exp_f32 v58, v58
  v_smfmac_f32_32x32x32_bf16 v[72:87], v[28:31], v[48:55], v4
  v_exp_f32 v59, v59
  v_exp_f32 v60, v60
  s_waitcnt lgkmcnt(0)
  v_mfma_f32_32x32x16_bf16 v[40:55], v[20:23], v[216:219], v[104:119]
  v_exp_f32 v61, v61
  v_exp_f32 v62, v62
  v_exp_f32 v63, v63
  v_exp_f32 v64, v64
  v_exp_f32 v65, v65
  v_exp_f32 v66, v66
  v_smfmac_f32_32x32x32_bf16 v[88:103], v[24:27], v[56:63], v4
  v_exp_f32 v67, v67
  v_exp_f32 v68, v68
  v_exp_f32 v69, v69
  v_exp_f32 v70, v70
  v_exp_f32 v71, v71
  v_exp_f32 v40, v40
  v_exp_f32 v41, v41
  v_exp_f32 v42, v42
  v_smfmac_f32_32x32x32_bf16 v[88:103], v[28:31], v[64:71], v4
  v_exp_f32 v43, v43
  v_exp_f32 v44, v44
  v_mfma_f32_32x32x16_bf16 v[56:71], v[20:23], v[220:223], v[120:135]
  v_exp_f32 v45, v45
  v_exp_f32 v46, v46
  v_exp_f32 v47, v47
  ds_read_b128 v[16:19], v2 offset:10240
  s_mov_b64 exec, s[56:57]
  ds_read_b128 v[24:27], v3 offset:10240
  ds_read_b128 v[28:31], v3 offset:10752
  s_mov_b64 exec, -1
  v_exp_f32 v48, v48
  v_exp_f32 v49, v49
  v_exp_f32 v50, v50
  v_smfmac_f32_32x32x32_bf16 v[72:87], v[32:35], v[40:47], v4
  v_exp_f32 v51, v51
  v_exp_f32 v52, v52
  v_exp_f32 v53, v53
  v_exp_f32 v54, v54
  v_exp_f32 v55, v55
  v_exp_f32 v56, v56
  v_exp_f32 v57, v57
  v_exp_f32 v58, v58
  v_smfmac_f32_32x32x32_bf16 v[72:87], v[36:39], v[48:55], v4
  v_exp_f32 v59, v59
  v_exp_f32 v60, v60
  s_waitcnt lgkmcnt(0)
  v_mfma_f32_32x32x16_bf16 v[40:55], v[16:19], v[216:219], v[104:119]
  v_exp_f32 v61, v61
  v_exp_f32 v62, v62
  v_exp_f32 v63, v63
  v_exp_f32 v64, v64
  v_exp_f32 v65, v65
  v_exp_f32 v66, v66
  v_smfmac_f32_32x32x32_bf16 v[88:103], v[32:35], v[56:63], v4
  v_exp_f32 v67, v67
  v_exp_f32 v68, v68
  v_exp_f32 v69, v69
  v_exp_f32 v70, v70
  v_exp_f32 v71, v71
  v_exp_f32 v40, v40
  v_exp_f32 v41, v41
  v_exp_f32 v42, v42
  v_smfmac_f32_32x32x32_bf16 v[88:103], v[36:39], v[64:71], v4
  v_exp_f32 v43, v43
  v_exp_f32 v44, v44
  v_mfma_f32_32x32x16_bf16 v[56:71], v[16:19], v[220:223], v[120:135]
  v_exp_f32 v45, v45
  v_exp_f32 v46, v46
  v_exp_f32 v47, v47
  ds_read_b128 v[20:23], v2 offset:11264
  s_mov_b64 exec, s[56:57]
  ds_read_b128 v[32:35], v3 offset:11264
  ds_read_b128 v[36:39], v3 offset:11776
  s_mov_b64 exec, -1
  v_exp_f32 v48, v48
  v_exp_f32 v49, v49
  v_exp_f32 v50, v50
  v_smfmac_f32_32x32x32_bf16 v[72:87], v[24:27], v[40:47], v4
  v_exp_f32 v51, v51
  v_exp_f32 v52, v52
  v_exp_f32 v53, v53
  v_exp_f32 v54, v54
  v_exp_f32 v55, v55
  v_exp_f32 v56, v56
  v_exp_f32 v57, v57
  v_exp_f32 v58, v58
  v_smfmac_f32_32x32x32_bf16 v[72:87], v[28:31], v[48:55], v4
  v_exp_f32 v59, v59
  v_exp_f32 v60, v60
  s_waitcnt lgkmcnt(0)
  v_mfma_f32_32x32x16_bf16 v[40:55], v[20:23], v[216:219], v[104:119]
  v_exp_f32 v61, v61
  v_exp_f32 v62, v62
  v_exp_f32 v63, v63
  v_exp_f32 v64, v64
  v_exp_f32 v65, v65
  v_exp_f32 v66, v66
  v_smfmac_f32_32x32x32_bf16 v[88:103], v[24:27], v[56:63], v4
  v_exp_f32 v67, v67
  v_exp_f32 v68, v68
  v_exp_f32 v69, v69
  v_exp_f32 v70, v70
  v_exp_f32 v71, v71
  v_exp_f32 v40, v40
  v_exp_f32 v41, v41
  v_exp_f32 v42, v42
  v_smfmac_f32_32x32x32_bf16 v[88:103], v[28:31], v[64:71], v4
  v_exp_f32 v43, v43
  v_exp_f32 v44, v44
  v_mfma_f32_32x32x16_bf16 v[56:71], v[20:23], v[220:223], v[120:135]
  v_exp_f32 v45, v45
  v_exp_f32 v46, v46
  v_exp_f32 v47, v47
  ds_read_b128 v[16:19], v2 offset:12288
  s_mov_b64 exec, s[56:57]
  ds_read_b128 v[24:27], v3 offset:12288
  ds_read_b128 v[28:31], v3 offset:12800
  s_mov_b64 exec, -1
  v_exp_f32 v48, v48
  v_exp_f32 v49, v49
  v_exp_f32 v50, v50
  v_smfmac_f32_32x32x32_bf16 v[72:87], v[32:35], v[40:47], v4
  v_exp_f32 v51, v51
  v_exp_f32 v52, v52
  v_exp_f32 v53, v53
  v_exp_f32 v54, v54
  v_exp_f32 v55, v55
  v_exp_f32 v56, v56
  v_exp_f32 v57, v57
  v_exp_f32 v58, v58
  v_smfmac_f32_32x32x32_bf16 v[72:87], v[36:39], v[48:55], v4
  v_exp_f32 v59, v59
  v_exp_f32 v60, v60
  s_waitcnt lgkmcnt(0)
  v_mfma_f32_32x32x16_bf16 v[40:55], v[16:19], v[216:219], v[104:119]
  v_exp_f32 v61, v61
  v_exp_f32 v62, v62
  v_exp_f32 v63, v63
  v_exp_f32 v64, v64
  v_exp_f32 v65, v65
  v_exp_f32 v66, v66
  v_smfmac_f32_32x32x32_bf16 v[88:103], v[32:35], v[56:63], v4
  v_exp_f32 v67, v67
  v_exp_f32 v68, v68
  v_exp_f32 v69, v69
  v_exp_f32 v70, v70
  v_exp_f32 v71, v71
  v_exp_f32 v40, v40
  v_exp_f32 v41, v41
  v_exp_f32 v42, v42
  v_smfmac_f32_32x32x32_bf16 v[88:103], v[36:39], v[64:71], v4
  v_exp_f32 v43, v43
  v_exp_f32 v44, v44
  v_mfma_f32_32x32x16_bf16 v[56:71], v[16:19], v[220:223], v[120:135]
  v_exp_f32 v45, v45
  v_exp_f32 v46, v46
  v_exp_f32 v47, v47
  ds_read_b128 v[20:23], v2 offset:13312
  s_mov_b64 exec, s[56:57]
  ds_read_b128 v[32:35], v3 offset:13312
  ds_read_b128 v[36:39], v3 offset:13824
  s_mov_b64 exec, -1
  v_exp_f32 v48, v48
  v_exp_f32 v49, v49
  v_exp_f32 v50, v50
  v_smfmac_f32_32x32x32_bf16 v[72:87], v[24:27], v[40:47], v4
  v_exp_f32 v51, v51
  v_exp_f32 v52, v52
  v_exp_f32 v53, v53
  v_exp_f32 v54, v54
  v_exp_f32 v55, v55
  v_exp_f32 v56, v56
  v_exp_f32 v57, v57
  v_exp_f32 v58, v58
  v_smfmac_f32_32x32x32_bf16 v[72:87], v[28:31], v[48:55], v4
  v_exp_f32 v59, v59
  v_exp_f32 v60, v60
  s_waitcnt lgkmcnt(0)
  v_mfma_f32_32x32x16_bf16 v[40:55], v[20:23], v[216:219], v[104:119]
  v_exp_f32 v61, v61
  v_exp_f32 v62, v62
  v_exp_f32 v63, v63
  v_exp_f32 v64, v64
  v_exp_f32 v65, v65
  v_exp_f32 v66, v66
  v_smfmac_f32_32x32x32_bf16 v[88:103], v[24:27], v[56:63], v4
  v_exp_f32 v67, v67
  v_exp_f32 v68, v68
  v_exp_f32 v69, v69
  v_exp_f32 v70, v70
  v_exp_f32 v71, v71
  v_exp_f32 v40, v40
  v_exp_f32 v41, v41
  v_exp_f32 v42, v42
  v_smfmac_f32_32x32x32_bf16 v[88:103], v[28:31], v[64:71], v4
  v_exp_f32 v43, v43
  v_exp_f32 v44, v44
  v_mfma_f32_32x32x16_bf16 v[56:71], v[20:23], v[220:223], v[120:135]
  v_exp_f32 v45, v45
  v_exp_f32 v46, v46
  v_exp_f32 v47, v47
  ds_read_b128 v[16:19], v2 offset:14336
  s_mov_b64 exec, s[56:57]
  ds_read_b128 v[24:27], v3 offset:14336
  ds_read_b128 v[28:31], v3 offset:14848
  s_mov_b64 exec, -1
  v_exp_f32 v48, v48
  v_exp_f32 v49, v49
  v_exp_f32 v50, v50
  v_smfmac_f32_32x32x32_bf16 v[72:87], v[32:35], v[40:47], v4
  v_exp_f32 v51, v51
  v_exp_f32 v52, v52
  v_exp_f32 v53, v53
  v_exp_f32 v54, v54
  v_exp_f32 v55, v55
  v_exp_f32 v56, v56
  v_exp_f32 v57, v57
  v_exp_f32 v58, v58
  v_smfmac_f32_32x32x32_bf16 v[72:87], v[36:39], v[48:55], v4
  v_exp_f32 v59, v59
  v_exp_f32 v60, v60
  s_waitcnt lgkmcnt(0)
  v_mfma_f32_32x32x16_bf16 v[40:55], v[16:19], v[216:219], v[104:119]
  v_exp_f32 v61, v61
  v_exp_f32 v62, v62
  v_exp_f32 v63, v63
  v_exp_f32 v64, v64
  v_exp_f32 v65, v65
  v_exp_f32 v66, v66
  v_smfmac_f32_32x32x32_bf16 v[88:103], v[32:35], v[56:63], v4
  v_exp_f32 v67, v67
  v_exp_f32 v68, v68
  v_exp_f32 v69, v69
  v_exp_f32 v70, v70
  v_exp_f32 v71, v71
  s_waitcnt vmcnt(0)
  s_barrier
  s_cmp_lg_u32 s24, 0
  s_cbranch_scc1 L_pi_16
  global_load_dword v254, v7, s[20:21] sc1
L_pi_16:
  v_exp_f32 v40, v40
  v_exp_f32 v41, v41
  v_exp_f32 v42, v42
  v_smfmac_f32_32x32x32_bf16 v[88:103], v[36:39], v[64:71], v4
  v_exp_f32 v43, v43
  v_exp_f32 v44, v44
  v_mfma_f32_32x32x16_bf16 v[56:71], v[16:19], v[220:223], v[120:135]
  v_exp_f32 v45, v45
  v_exp_f32 v46, v46
  v_exp_f32 v47, v47
  ds_read_b128 v[20:23], v2 offset:15360
  s_mov_b64 exec, s[56:57]
  ds_read_b128 v[32:35], v3 offset:15360
  ds_read_b128 v[36:39], v3 offset:15872
  s_mov_b64 exec, -1
  v_exp_f32 v48, v48
  v_exp_f32 v49, v49
  v_exp_f32 v50, v50
  v_smfmac_f32_32x32x32_bf16 v[72:87], v[24:27], v[40:47], v4
  v_exp_f32 v51, v51
  v_exp_f32 v52, v52
  v_exp_f32 v53, v53
  v_exp_f32 v54, v54
  v_exp_f32 v55, v55
  v_exp_f32 v56, v56
  v_exp_f32 v57, v57
  v_exp_f32 v58, v58
  v_smfmac_f32_32x32x32_bf16 v[72:87], v[28:31], v[48:55], v4
  v_exp_f32 v59, v59
  v_exp_f32 v60, v60
  s_waitcnt lgkmcnt(0)
  v_mfma_f32_32x32x16_bf16 v[40:55], v[20:23], v[216:219], v[104:119]
  v_exp_f32 v61, v61
  v_exp_f32 v62, v62
  v_exp_f32 v63, v63
  v_exp_f32 v64, v64
  v_exp_f32 v65, v65
  v_exp_f32 v66, v66
  v_smfmac_f32_32x32x32_bf16 v[88:103], v[24:27], v[56:63], v4
  v_exp_f32 v67, v67
  v_exp_f32 v68, v68
  v_exp_f32 v69, v69
  v_exp_f32 v70, v70
  v_exp_f32 v71, v71
  v_exp_f32 v40, v40
  v_exp_f32 v41, v41
  v_exp_f32 v42, v42
  v_smfmac_f32_32x32x32_bf16 v[88:103], v[28:31], v[64:71], v4
  v_exp_f32 v43, v43
  v_exp_f32 v44, v44
  v_mfma_f32_32x32x16_bf16 v[56:71], v[20:23], v[220:223], v[120:135]
  v_exp_f32 v45, v45
  v_exp_f32 v46, v46
  v_exp_f32 v47, v47
  ds_read_b128 v[16:19], v2 offset:16384
  s_mov_b64 exec, s[56:57]
  ds_read_b128 v[24:27], v3 offset:16384
  ds_read_b128 v[28:31], v3 offset:16896
  s_mov_b64 exec, -1
  v_exp_f32 v48, v48
  v_exp_f32 v49, v49
  v_exp_f32 v50, v50
  v_smfmac_f32_32x32x32_bf16 v[72:87], v[32:35], v[40:47], v4
  v_exp_f32 v51, v51
  v_exp_f32 v52, v52
  v_exp_f32 v53, v53
  v_exp_f32 v54, v54
  v_exp_f32 v55, v55
  v_exp_f32 v56, v56
  v_exp_f32 v57, v57
  v_exp_f32 v58, v58
  v_smfmac_f32_32x32x32_bf16 v[72:87], v[36:39], v[48:55], v4
  v_exp_f32 v59, v59
  v_exp_f32 v60, v60
  s_waitcnt lgkmcnt(0)
  v_mfma_f32_32x32x16_bf16 v[40:55], v[16:19], v[216:219], v[104:119]
  v_exp_f32 v61, v61
  v_exp_f32 v62, v62
  v_exp_f32 v63, v63
  v_exp_f32 v64, v64
  v_exp_f32 v65, v65
  v_exp_f32 v66, v66
  v_smfmac_f32_32x32x32_bf16 v[88:103], v[32:35], v[56:63], v4
  v_exp_f32 v67, v67
  v_exp_f32 v68, v68
  v_exp_f32 v69, v69
  v_exp_f32 v70, v70
  v_exp_f32 v71, v71
  s_cmp_lg_u32 s25, 0
  s_cbranch_scc1 L_cpf0
  s_lshr_b32 s29, s2, 3
  s_lshl_b32 s29, s29, 9
  s_lshl_b32 s30, s24, 6
  s_add_u32 s29, s29, s30
  v_add_u32 v5, s29, v0
  v_lshlrev_b32 v5, 7, v5
  s_mov_b32 s12, s38
  s_mov_b32 s13, s39
  s_mov_b32 s14, 1409024
  buffer_load_dword v163, v5, s[12:15], 0 offen
  v_subrev_u32 v6, 1409024, v5
  s_mov_b32 s16, s40
  s_mov_b32 s17, s41
  s_mov_b32 s18, 524288
  buffer_load_dword v164, v6, s[16:19], 0 offen
L_cpf0:
  v_exp_f32 v40, v40
  v_exp_f32 v41, v41
  v_exp_f32 v42, v42
  v_smfmac_f32_32x32x32_bf16 v[88:103], v[36:39], v[64:71], v4
  v_exp_f32 v43, v43
  v_exp_f32 v44, v44
  v_mfma_f32_32x32x16_bf16 v[56:71], v[16:19], v[220:223], v[120:135]
  v_exp_f32 v45, v45
  v_exp_f32 v46, v46
  v_exp_f32 v47, v47
  ds_read_b128 v[20:23], v2 offset:17408
  s_mov_b64 exec, s[56:57]
  ds_read_b128 v[32:35], v3 offset:17408
  ds_read_b128 v[36:39], v3 offset:17920
  s_mov_b64 exec, -1
  v_exp_f32 v48, v48
  v_exp_f32 v49, v49
  v_exp_f32 v50, v50
  v_smfmac_f32_32x32x32_bf16 v[72:87], v[24:27], v[40:47], v4
  v_exp_f32 v51, v51
  v_exp_f32 v52, v52
  v_exp_f32 v53, v53
  v_exp_f32 v54, v54
  v_exp_f32 v55, v55
  v_exp_f32 v56, v56
  v_exp_f32 v57, v57
  v_exp_f32 v58, v58
  v_smfmac_f32_32x32x32_bf16 v[72:87], v[28:31], v[48:55], v4
  v_exp_f32 v59, v59
  v_exp_f32 v60, v60
  s_waitcnt lgkmcnt(0)
  v_mfma_f32_32x32x16_bf16 v[40:55], v[20:23], v[216:219], v[104:119]
  v_exp_f32 v61, v61
  v_exp_f32 v62, v62
  v_exp_f32 v63, v63
  v_exp_f32 v64, v64
  v_exp_f32 v65, v65
  v_exp_f32 v66, v66
  v_smfmac_f32_32x32x32_bf16 v[88:103], v[24:27], v[56:63], v4
  v_exp_f32 v67, v67
  v_exp_f32 v68, v68
  v_exp_f32 v69, v69
  v_exp_f32 v70, v70
  v_exp_f32 v71, v71
  s_cmp_lg_u32 s25, 1
  s_cbranch_scc1 L_cpf1
  s_lshr_b32 s29, s2, 3
  s_lshl_b32 s29, s29, 9
  s_lshl_b32 s30, s24, 6
  s_add_u32 s29, s29, s30
  v_add_u32 v5, s29, v0
  v_lshlrev_b32 v5, 7, v5
  s_mov_b32 s12, s38
  s_mov_b32 s13, s39
  s_mov_b32 s14, 1409024
  buffer_load_dword v163, v5, s[12:15], 0 offen
  v_subrev_u32 v6, 1409024, v5
  s_mov_b32 s16, s40
  s_mov_b32 s17, s41
  s_mov_b32 s18, 524288
  buffer_load_dword v164, v6, s[16:19], 0 offen
L_cpf1:
  v_exp_f32 v40, v40
  v_exp_f32 v41, v41
  v_exp_f32 v42, v42
  v_smfmac_f32_32x32x32_bf16 v[88:103], v[28:31], v[64:71], v4
  v_exp_f32 v43, v43
  v_exp_f32 v44, v44
  v_mfma_f32_32x32x16_bf16 v[56:71], v[20:23], v[220:223], v[120:135]
  v_exp_f32 v45, v45
  v_exp_f32 v46, v46
  v_exp_f32 v47, v47
  ds_read_b128 v[16:19], v2 offset:18432
  s_mov_b64 exec, s[56:57]
  ds_read_b128 v[24:27], v3 offset:18432
  ds_read_b128 v[28:31], v3 offset:18944
  s_mov_b64 exec, -1
  v_exp_f32 v48, v48
  v_exp_f32 v49, v49
  v_exp_f32 v50, v50
  v_smfmac_f32_32x32x32_bf16 v[72:87], v[32:35], v[40:47], v4
  v_exp_f32 v51, v51
  v_exp_f32 v52, v52
  v_exp_f32 v53, v53
  v_exp_f32 v54, v54
  v_exp_f32 v55, v55
  v_exp_f32 v56, v56
  v_exp_f32 v57, v57
  v_exp_f32 v58, v58
  v_smfmac_f32_32x32x32_bf16 v[72:87], v[36:39], v[48:55], v4
  v_exp_f32 v59, v59
  v_exp_f32 v60, v60
  s_waitcnt lgkmcnt(0)
  v_mfma_f32_32x32x16_bf16 v[40:55], v[16:19], v[216:219], v[104:119]
  v_exp_f32 v61, v61
  v_exp_f32 v62, v62
  v_exp_f32 v63, v63
  v_exp_f32 v64, v64
  v_exp_f32 v65, v65
  v_exp_f32 v66, v66
  v_smfmac_f32_32x32x32_bf16 v[88:103], v[32:35], v[56:63], v4
  v_exp_f32 v67, v67
  v_exp_f32 v68, v68
  v_exp_f32 v69, v69
  v_exp_f32 v70, v70
  v_exp_f32 v71, v71
  s_cmp_lg_u32 s25, 2
  s_cbranch_scc1 L_cpf2
  s_lshr_b32 s29, s2, 3
  s_lshl_b32 s29, s29, 9
  s_lshl_b32 s30, s24, 6
  s_add_u32 s29, s29, s30
  v_add_u32 v5, s29, v0
  v_lshlrev_b32 v5, 7, v5
  s_mov_b32 s12, s38
  s_mov_b32 s13, s39
  s_mov_b32 s14, 1409024
  buffer_load_dword v163, v5, s[12:15], 0 offen
  v_subrev_u32 v6, 1409024, v5
  s_mov_b32 s16, s40
  s_mov_b32 s17, s41
  s_mov_b32 s18, 524288
  buffer_load_dword v164, v6, s[16:19], 0 offen
L_cpf2:
  v_exp_f32 v40, v40
  v_exp_f32 v41, v41
  v_exp_f32 v42, v42
  v_smfmac_f32_32x32x32_bf16 v[88:103], v[36:39], v[64:71], v4
  v_exp_f32 v43, v43
  v_exp_f32 v44, v44
  v_mfma_f32_32x32x16_bf16 v[56:71], v[16:19], v[220:223], v[120:135]
  v_exp_f32 v45, v45
  v_exp_f32 v46, v46
  v_exp_f32 v47, v47
  ds_read_b128 v[20:23], v2 offset:19456
  s_mov_b64 exec, s[56:57]
  ds_read_b128 v[32:35], v3 offset:19456
  ds_read_b128 v[36:39], v3 offset:19968
  s_mov_b64 exec, -1
  v_exp_f32 v48, v48
  v_exp_f32 v49, v49
  v_exp_f32 v50, v50
  v_smfmac_f32_32x32x32_bf16 v[72:87], v[24:27], v[40:47], v4
  v_exp_f32 v51, v51
  v_exp_f32 v52, v52
  v_exp_f32 v53, v53
  v_exp_f32 v54, v54
  v_exp_f32 v55, v55
  v_exp_f32 v56, v56
  v_exp_f32 v57, v57
  v_exp_f32 v58, v58
  v_smfmac_f32_32x32x32_bf16 v[72:87], v[28:31], v[48:55], v4
  v_exp_f32 v59, v59
  v_exp_f32 v60, v60
  s_waitcnt lgkmcnt(0)
  v_mfma_f32_32x32x16_bf16 v[40:55], v[20:23], v[216:219], v[104:119]
  v_exp_f32 v61, v61
  v_exp_f32 v62, v62
  v_exp_f32 v63, v63
  v_exp_f32 v64, v64
  v_exp_f32 v65, v65
  v_exp_f32 v66, v66
  v_smfmac_f32_32x32x32_bf16 v[88:103], v[24:27], v[56:63], v4
  v_exp_f32 v67, v67
  v_exp_f32 v68, v68
  v_exp_f32 v69, v69
  v_exp_f32 v70, v70
  v_exp_f32 v71, v71
  s_cmp_lg_u32 s25, 3
  s_cbranch_scc1 L_cpf3
  s_lshr_b32 s29, s2, 3
  s_lshl_b32 s29, s29, 9
  s_lshl_b32 s30, s24, 6
  s_add_u32 s29, s29, s30
  v_add_u32 v5, s29, v0
  v_lshlrev_b32 v5, 7, v5
  s_mov_b32 s12, s38
  s_mov_b32 s13, s39
  s_mov_b32 s14, 1409024
  buffer_load_dword v163, v5, s[12:15], 0 offen
  v_subrev_u32 v6, 1409024, v5
  s_mov_b32 s16, s40
  s_mov_b32 s17, s41
  s_mov_b32 s18, 524288
  buffer_load_dword v164, v6, s[16:19], 0 offen
L_cpf3:
  v_exp_f32 v40, v40
  v_exp_f32 v41, v41
  v_exp_f32 v42, v42
  v_smfmac_f32_32x32x32_bf16 v[88:103], v[28:31], v[64:71], v4
  v_exp_f32 v43, v43
  v_exp_f32 v44, v44
  v_mfma_f32_32x32x16_bf16 v[56:71], v[20:23], v[220:223], v[120:135]
  v_exp_f32 v45, v45
  v_exp_f32 v46, v46
  v_exp_f32 v47, v47
  ds_read_b128 v[16:19], v2 offset:20480
  s_mov_b64 exec, s[56:57]
  ds_read_b128 v[24:27], v3 offset:20480
  ds_read_b128 v[28:31], v3 offset:20992
  s_mov_b64 exec, -1
  v_exp_f32 v48, v48
  v_exp_f32 v49, v49
  v_exp_f32 v50, v50
  v_smfmac_f32_32x32x32_bf16 v[72:87], v[32:35], v[40:47], v4
  v_exp_f32 v51, v51
  v_exp_f32 v52, v52
  v_exp_f32 v53, v53
  v_exp_f32 v54, v54
  v_exp_f32 v55, v55
  v_exp_f32 v56, v56
  v_exp_f32 v57, v57
  v_exp_f32 v58, v58
  v_smfmac_f32_32x32x32_bf16 v[72:87], v[36:39], v[48:55], v4
  v_exp_f32 v59, v59
  v_exp_f32 v60, v60
  s_waitcnt lgkmcnt(0)
  v_mfma_f32_32x32x16_bf16 v[40:55], v[16:19], v[216:219], v[104:119]
  v_exp_f32 v61, v61
  v_exp_f32 v62, v62
  v_exp_f32 v63, v63
  v_exp_f32 v64, v64
  v_exp_f32 v65, v65
  v_exp_f32 v66, v66
  v_smfmac_f32_32x32x32_bf16 v[88:103], v[32:35], v[56:63], v4
  v_exp_f32 v67, v67
  v_exp_f32 v68, v68
  v_exp_f32 v69, v69
  v_exp_f32 v70, v70
  v_exp_f32 v71, v71
  v_exp_f32 v40, v40
  v_exp_f32 v41, v41
  v_exp_f32 v42, v42
  v_smfmac_f32_32x32x32_bf16 v[88:103], v[36:39], v[64:71], v4
  v_exp_f32 v43, v43
  v_exp_f32 v44, v44
  v_mfma_f32_32x32x16_bf16 v[56:71], v[16:19], v[220:223], v[120:135]
  v_exp_f32 v45, v45
  v_exp_f32 v46, v46
  v_exp_f32 v47, v47
  ds_read_b128 v[20:23], v2 offset:21504
  s_mov_b64 exec, s[56:57]
  ds_read_b128 v[32:35], v3 offset:21504
  ds_read_b128 v[36:39], v3 offset:22016
  s_mov_b64 exec, -1
  v_exp_f32 v48, v48
  v_exp_f32 v49, v49
  v_exp_f32 v50, v50
  v_smfmac_f32_32x32x32_bf16 v[72:87], v[24:27], v[40:47], v4
  v_exp_f32 v51, v51
  v_exp_f32 v52, v52
  v_exp_f32 v53, v53
  v_exp_f32 v54, v54
  v_exp_f32 v55, v55
  v_exp_f32 v56, v56
  v_exp_f32 v57, v57
  v_exp_f32 v58, v58
  v_smfmac_f32_32x32x32_bf16 v[72:87], v[28:31], v[48:55], v4
  v_exp_f32 v59, v59
  v_exp_f32 v60, v60
  s_waitcnt lgkmcnt(0)
  v_mfma_f32_32x32x16_bf16 v[40:55], v[20:23], v[216:219], v[104:119]
  v_exp_f32 v61, v61
  v_exp_f32 v62, v62
  v_exp_f32 v63, v63
  v_exp_f32 v64, v64
  v_exp_f32 v65, v65
  v_exp_f32 v66, v66
  v_smfmac_f32_32x32x32_bf16 v[88:103], v[24:27], v[56:63], v4
  v_exp_f32 v67, v67
  v_exp_f32 v68, v68
  v_exp_f32 v69, v69
  v_exp_f32 v70, v70
  v_exp_f32 v71, v71
  v_lshrrev_b32 v165, 3, v0
  v_lshrrev_b32 v166, 4, v0
  v_and_b32 v166, 1, v166
  v_lshlrev_b32 v166, 2, v166
  v_and_b32 v167, 7, v0
  v_xor_b32 v166, v166, v167
  v_lshlrev_b32 v166, 4, v166
  v_lshl_add_u32 v224, v165, 10, v166
  s_lshl_b32 s29, s59, 7
  v_add_u32 v224, s29, v224
  s_mov_b32 s16, s36
  s_mov_b32 s17, s37
  s_mov_b32 s18, 2097152
  s_mov_b32 s4, s38
  s_mov_b32 s5, s39
  s_mov_b32 s6, 1409024
  s_mov_b32 s7, 0x20000
  s_lshr_b32 s29, s25, 1
  s_lshl_b32 s30, s58, 1
  s_add_u32 s30, s30, s29
  s_mul_i32 s31, s30, 86
  s_and_b32 s32, s25, 1
  s_lshl_b32 s32, s32, 2
  s_add_u32 s31, s31, s32
  s_lshl_b32 s31, s31, 10
  s_add_u32 s60, s31, 6291456
  s_lshl_b32 s30, s30, 5
  s_add_u32 s30, s30, s32
  s_lshl_b32 s30, s30, 10
  s_add_u32 s61, s30, 11927552
  s_lshl_b32 s29, s29, 15
  s_lshl_b32 s32, s32, 10
  s_add_u32 s62, s29, s32
  s_add_u32 s68, s62, 65536
  s_lshl_b32 s67, s25, 15
  s_mov_b32 s63, 0
  v_exp_f32 v40, v40
  v_exp_f32 v41, v41
  v_exp_f32 v42, v42
  v_smfmac_f32_32x32x32_bf16 v[88:103], v[28:31], v[64:71], v4
  v_exp_f32 v43, v43
  v_exp_f32 v44, v44
  v_mfma_f32_32x32x16_bf16 v[56:71], v[20:23], v[220:223], v[120:135]
  v_exp_f32 v45, v45
  v_exp_f32 v46, v46
  v_exp_f32 v47, v47
  ds_read_b128 v[16:19], v2 offset:22528
  s_mov_b64 exec, s[56:57]
  ds_read_b128 v[24:27], v3 offset:22528
  ds_read_b128 v[28:31], v3 offset:23040
  s_mov_b64 exec, -1
  v_exp_f32 v48, v48
  v_exp_f32 v49, v49
  v_exp_f32 v50, v50
  v_smfmac_f32_32x32x32_bf16 v[72:87], v[32:35], v[40:47], v4
  v_exp_f32 v51, v51
  v_exp_f32 v52, v52
  v_exp_f32 v53, v53
  v_exp_f32 v54, v54
  v_exp_f32 v55, v55
  v_exp_f32 v56, v56
  v_exp_f32 v57, v57
  v_exp_f32 v58, v58
  v_smfmac_f32_32x32x32_bf16 v[72:87], v[36:39], v[48:55], v4
  v_exp_f32 v59, v59
  v_exp_f32 v60, v60
  s_waitcnt lgkmcnt(0)
  v_mfma_f32_32x32x16_bf16 v[40:55], v[16:19], v[216:219], v[104:119]
  v_exp_f32 v61, v61
  v_exp_f32 v62, v62
  v_exp_f32 v63, v63
  v_exp_f32 v64, v64
  v_exp_f32 v65, v65
  v_exp_f32 v66, v66
  v_smfmac_f32_32x32x32_bf16 v[88:103], v[32:35], v[56:63], v4
  v_exp_f32 v67, v67
  v_exp_f32 v68, v68
  v_exp_f32 v69, v69
  v_exp_f32 v70, v70
  v_exp_f32 v71, v71
  s_cmp_lg_u32 s24, 0
  s_cbranch_scc1 L_hpf
  s_waitcnt vmcnt(2)
  v_cmp_ne_u32 vcc, s3, v254
  s_nop 4
  s_cmp_eq_u64 vcc, 0
  s_cbranch_scc0 L_hpf
  s_mul_i32 s29, s58, 176128
  s_mul_i32 s30, s59, 22016
  s_add_u32 s29, s29, s30
  s_add_u32 s29, s29, 6291456
  v_lshlrev_b32 v5, 7, v0
  buffer_load_dword v160, v5, s[20:23], s29 offen
  v_add_u32 v5, 8192, v5
  buffer_load_dword v161, v5, s[20:23], s29 offen
  v_add_u32 v5, 8192, v5
  v_min_u32 v5, 21888, v5
  buffer_load_dword v162, v5, s[20:23], s29 offen
L_hpf:
  v_exp_f32 v40, v40
  v_exp_f32 v41, v41
  v_exp_f32 v42, v42
  v_smfmac_f32_32x32x32_bf16 v[88:103], v[36:39], v[64:71], v4
  v_exp_f32 v43, v43
  v_exp_f32 v44, v44
  v_mfma_f32_32x32x16_bf16 v[56:71], v[16:19], v[220:223], v[120:135]
  v_exp_f32 v45, v45
  v_exp_f32 v46, v46
  v_exp_f32 v47, v47
  ds_read_b128 v[20:23], v2 offset:23552
  s_mov_b64 exec, s[56:57]
  ds_read_b128 v[32:35], v3 offset:23552
  ds_read_b128 v[36:39], v3 offset:24064
  s_mov_b64 exec, -1
  v_exp_f32 v48, v48
  v_exp_f32 v49, v49
  v_exp_f32 v50, v50
  v_smfmac_f32_32x32x32_bf16 v[72:87], v[24:27], v[40:47], v4
  v_exp_f32 v51, v51
  v_exp_f32 v52, v52
  v_exp_f32 v53, v53
  v_exp_f32 v54, v54
  v_exp_f32 v55, v55
  v_exp_f32 v56, v56
  v_exp_f32 v57, v57
  v_exp_f32 v58, v58
  v_smfmac_f32_32x32x32_bf16 v[72:87], v[28:31], v[48:55], v4
  v_exp_f32 v59, v59
  v_exp_f32 v60, v60
  s_waitcnt lgkmcnt(0)
  v_mfma_f32_32x32x16_bf16 v[40:55], v[20:23], v[216:219], v[104:119]
  v_exp_f32 v61, v61
  v_exp_f32 v62, v62
  v_exp_f32 v63, v63
  v_exp_f32 v64, v64
  v_exp_f32 v65, v65
  v_exp_f32 v66, v66
  v_smfmac_f32_32x32x32_bf16 v[88:103], v[24:27], v[56:63], v4
  v_exp_f32 v67, v67
  v_exp_f32 v68, v68
  v_exp_f32 v69, v69
  v_exp_f32 v70, v70
  v_exp_f32 v71, v71
  v_exp_f32 v40, v40
  v_exp_f32 v41, v41
  v_exp_f32 v42, v42
  v_smfmac_f32_32x32x32_bf16 v[88:103], v[28:31], v[64:71], v4
  v_exp_f32 v43, v43
  v_exp_f32 v44, v44
  v_mfma_f32_32x32x16_bf16 v[56:71], v[20:23], v[220:223], v[120:135]
  v_exp_f32 v45, v45
  v_exp_f32 v46, v46
  v_exp_f32 v47, v47
  ds_read_b128 v[16:19], v2 offset:24576
  s_mov_b64 exec, s[56:57]
  ds_read_b128 v[24:27], v3 offset:24576
  ds_read_b128 v[28:31], v3 offset:25088
  s_mov_b64 exec, -1
  v_exp_f32 v48, v48
  v_exp_f32 v49, v49
  v_exp_f32 v50, v50
  v_smfmac_f32_32x32x32_bf16 v[72:87], v[32:35], v[40:47], v4
  v_exp_f32 v51, v51
  v_exp_f32 v52, v52
  v_exp_f32 v53, v53
  v_exp_f32 v54, v54
  v_exp_f32 v55, v55
  v_exp_f32 v56, v56
  v_exp_f32 v57, v57
  v_exp_f32 v58, v58
  v_smfmac_f32_32x32x32_bf16 v[72:87], v[36:39], v[48:55], v4
  v_exp_f32 v59, v59
  v_exp_f32 v60, v60
  s_waitcnt lgkmcnt(0)
  v_mfma_f32_32x32x16_bf16 v[40:55], v[16:19], v[216:219], v[104:119]
  v_exp_f32 v61, v61
  v_exp_f32 v62, v62
  v_exp_f32 v63, v63
  v_exp_f32 v64, v64
  v_exp_f32 v65, v65
  v_exp_f32 v66, v66
  v_smfmac_f32_32x32x32_bf16 v[88:103], v[32:35], v[56:63], v4
  v_exp_f32 v67, v67
  v_exp_f32 v68, v68
  v_exp_f32 v69, v69
  v_exp_f32 v70, v70
  v_exp_f32 v71, v71
  v_exp_f32 v40, v40
  v_exp_f32 v41, v41
  v_exp_f32 v42, v42
  v_smfmac_f32_32x32x32_bf16 v[88:103], v[36:39], v[64:71], v4
  v_exp_f32 v43, v43
  v_exp_f32 v44, v44
  v_mfma_f32_32x32x16_bf16 v[56:71], v[16:19], v[220:223], v[120:135]
  v_exp_f32 v45, v45
  v_exp_f32 v46, v46
  v_exp_f32 v47, v47
  ds_read_b128 v[20:23], v2 offset:25600
  s_mov_b64 exec, s[56:57]
  ds_read_b128 v[32:35], v3 offset:25600
  ds_read_b128 v[36:39], v3 offset:26112
  s_mov_b64 exec, -1
  v_exp_f32 v48, v48
  v_exp_f32 v49, v49
  v_exp_f32 v50, v50
  v_smfmac_f32_32x32x32_bf16 v[72:87], v[24:27], v[40:47], v4
  v_exp_f32 v51, v51
  v_exp_f32 v52, v52
  v_exp_f32 v53, v53
  v_exp_f32 v54, v54
  v_exp_f32 v55, v55
  v_exp_f32 v56, v56
  v_exp_f32 v57, v57
  v_exp_f32 v58, v58
  v_smfmac_f32_32x32x32_bf16 v[72:87], v[28:31], v[48:55], v4
  v_exp_f32 v59, v59
  v_exp_f32 v60, v60
  s_waitcnt lgkmcnt(0)
  v_mfma_f32_32x32x16_bf16 v[40:55], v[20:23], v[216:219], v[104:119]
  v_exp_f32 v61, v61
  v_exp_f32 v62, v62
  v_exp_f32 v63, v63
  v_exp_f32 v64, v64
  v_exp_f32 v65, v65
  v_exp_f32 v66, v66
  v_smfmac_f32_32x32x32_bf16 v[88:103], v[24:27], v[56:63], v4
  v_exp_f32 v67, v67
  v_exp_f32 v68, v68
  v_exp_f32 v69, v69
  v_exp_f32 v70, v70
  v_exp_f32 v71, v71
  v_exp_f32 v40, v40
  v_exp_f32 v41, v41
  v_exp_f32 v42, v42
  v_smfmac_f32_32x32x32_bf16 v[88:103], v[28:31], v[64:71], v4
  v_exp_f32 v43, v43
  v_exp_f32 v44, v44
  v_mfma_f32_32x32x16_bf16 v[56:71], v[20:23], v[220:223], v[120:135]
  v_exp_f32 v45, v45
  v_exp_f32 v46, v46
  v_exp_f32 v47, v47
  ds_read_b128 v[16:19], v2 offset:26624
  s_mov_b64 exec, s[56:57]
  ds_read_b128 v[24:27], v3 offset:26624
  ds_read_b128 v[28:31], v3 offset:27136
  s_mov_b64 exec, -1
  v_exp_f32 v48, v48
  v_exp_f32 v49, v49
  v_exp_f32 v50, v50
  v_smfmac_f32_32x32x32_bf16 v[72:87], v[32:35], v[40:47], v4
  v_exp_f32 v51, v51
  v_exp_f32 v52, v52
  v_exp_f32 v53, v53
  v_exp_f32 v54, v54
  v_exp_f32 v55, v55
  v_exp_f32 v56, v56
  v_exp_f32 v57, v57
  v_exp_f32 v58, v58
  v_smfmac_f32_32x32x32_bf16 v[72:87], v[36:39], v[48:55], v4
  v_exp_f32 v59, v59
  v_exp_f32 v60, v60
  s_waitcnt lgkmcnt(0)
  v_mfma_f32_32x32x16_bf16 v[40:55], v[16:19], v[216:219], v[104:119]
  v_exp_f32 v61, v61
  v_exp_f32 v62, v62
  v_exp_f32 v63, v63
  v_exp_f32 v64, v64
  v_exp_f32 v65, v65
  v_exp_f32 v66, v66
  v_smfmac_f32_32x32x32_bf16 v[88:103], v[32:35], v[56:63], v4
  v_exp_f32 v67, v67
  v_exp_f32 v68, v68
  v_exp_f32 v69, v69
  v_exp_f32 v70, v70
  v_exp_f32 v71, v71
  v_exp_f32 v40, v40
  v_exp_f32 v41, v41
  v_exp_f32 v42, v42
  v_smfmac_f32_32x32x32_bf16 v[88:103], v[36:39], v[64:71], v4
  v_exp_f32 v43, v43
  v_exp_f32 v44, v44
  v_mfma_f32_32x32x16_bf16 v[56:71], v[16:19], v[220:223], v[120:135]
  v_exp_f32 v45, v45
  v_exp_f32 v46, v46
  v_exp_f32 v47, v47
  ds_read_b128 v[20:23], v2 offset:27648
  s_mov_b64 exec, s[56:57]
  ds_read_b128 v[32:35], v3 offset:27648
  ds_read_b128 v[36:39], v3 offset:28160
  s_mov_b64 exec, -1
  v_exp_f32 v48, v48
  v_exp_f32 v49, v49
  v_exp_f32 v50, v50
  v_smfmac_f32_32x32x32_bf16 v[72:87], v[24:27], v[40:47], v4
  v_exp_f32 v51, v51
  v_exp_f32 v52, v52
  v_exp_f32 v53, v53
  v_exp_f32 v54, v54
  v_exp_f32 v55, v55
  v_exp_f32 v56, v56
  v_exp_f32 v57, v57
  v_exp_f32 v58, v58
  v_smfmac_f32_32x32x32_bf16 v[72:87], v[28:31], v[48:55], v4
  v_exp_f32 v59, v59
  v_exp_f32 v60, v60
  s_waitcnt lgkmcnt(0)
  v_mfma_f32_32x32x16_bf16 v[40:55], v[20:23], v[216:219], v[104:119]
  v_exp_f32 v61, v61
  v_exp_f32 v62, v62
  v_exp_f32 v63, v63
  v_exp_f32 v64, v64
  v_exp_f32 v65, v65
  v_exp_f32 v66, v66
  v_smfmac_f32_32x32x32_bf16 v[88:103], v[24:27], v[56:63], v4
  v_exp_f32 v67, v67
  v_exp_f32 v68, v68
  v_exp_f32 v69, v69
  v_exp_f32 v70, v70
  v_exp_f32 v71, v71
  v_exp_f32 v40, v40
  v_exp_f32 v41, v41
  v_exp_f32 v42, v42
  v_smfmac_f32_32x32x32_bf16 v[88:103], v[28:31], v[64:71], v4
  v_exp_f32 v43, v43
  v_exp_f32 v44, v44
  v_mfma_f32_32x32x16_bf16 v[56:71], v[20:23], v[220:223], v[120:135]
  v_exp_f32 v45, v45
  v_exp_f32 v46, v46
  v_exp_f32 v47, v47
  ds_read_b128 v[16:19], v2 offset:28672
  s_mov_b64 exec, s[56:57]
  ds_read_b128 v[24:27], v3 offset:28672
  ds_read_b128 v[28:31], v3 offset:29184
  s_mov_b64 exec, -1
  v_exp_f32 v48, v48
  v_exp_f32 v49, v49
  v_exp_f32 v50, v50
  v_smfmac_f32_32x32x32_bf16 v[72:87], v[32:35], v[40:47], v4
  v_exp_f32 v51, v51
  v_exp_f32 v52, v52
  v_exp_f32 v53, v53
  v_exp_f32 v54, v54
  v_exp_f32 v55, v55
  v_exp_f32 v56, v56
  v_exp_f32 v57, v57
  v_exp_f32 v58, v58
  v_smfmac_f32_32x32x32_bf16 v[72:87], v[36:39], v[48:55], v4
  v_exp_f32 v59, v59
  v_exp_f32 v60, v60
  s_waitcnt lgkmcnt(0)
  v_mfma_f32_32x32x16_bf16 v[40:55], v[16:19], v[216:219], v[104:119]
  v_exp_f32 v61, v61
  v_exp_f32 v62, v62
  v_exp_f32 v63, v63
  v_exp_f32 v64, v64
  v_exp_f32 v65, v65
  v_exp_f32 v66, v66
  v_smfmac_f32_32x32x32_bf16 v[88:103], v[32:35], v[56:63], v4
  v_exp_f32 v67, v67
  v_exp_f32 v68, v68
  v_exp_f32 v69, v69
  v_exp_f32 v70, v70
  v_exp_f32 v71, v71
  v_exp_f32 v40, v40
  v_exp_f32 v41, v41
  v_exp_f32 v42, v42
  v_smfmac_f32_32x32x32_bf16 v[88:103], v[36:39], v[64:71], v4
  v_exp_f32 v43, v43
  v_exp_f32 v44, v44
  v_mfma_f32_32x32x16_bf16 v[56:71], v[16:19], v[220:223], v[120:135]
  v_exp_f32 v45, v45
  v_exp_f32 v46, v46
  v_exp_f32 v47, v47
  ds_read_b128 v[20:23], v2 offset:29696
  s_mov_b64 exec, s[56:57]
  ds_read_b128 v[32:35], v3 offset:29696
  ds_read_b128 v[36:39], v3 offset:30208
  s_mov_b64 exec, -1
  v_exp_f32 v48, v48
  v_exp_f32 v49, v49
  v_exp_f32 v50, v50
  v_smfmac_f32_32x32x32_bf16 v[72:87], v[24:27], v[40:47], v4
  v_exp_f32 v51, v51
  v_exp_f32 v52, v52
  v_exp_f32 v53, v53
  v_exp_f32 v54, v54
  v_exp_f32 v55, v55
  v_exp_f32 v56, v56
  v_exp_f32 v57, v57
  v_exp_f32 v58, v58
  v_smfmac_f32_32x32x32_bf16 v[72:87], v[28:31], v[48:55], v4
  v_exp_f32 v59, v59
  v_exp_f32 v60, v60
  s_waitcnt lgkmcnt(0)
  v_mfma_f32_32x32x16_bf16 v[40:55], v[20:23], v[216:219], v[104:119]
  v_exp_f32 v61, v61
  v_exp_f32 v62, v62
  v_exp_f32 v63, v63
  v_exp_f32 v64, v64
  v_exp_f32 v65, v65
  v_exp_f32 v66, v66
  v_smfmac_f32_32x32x32_bf16 v[88:103], v[24:27], v[56:63], v4
  v_exp_f32 v67, v67
  v_exp_f32 v68, v68
  v_exp_f32 v69, v69
  v_exp_f32 v70, v70
  v_exp_f32 v71, v71
  v_exp_f32 v40, v40
  v_exp_f32 v41, v41
  v_exp_f32 v42, v42
  v_smfmac_f32_32x32x32_bf16 v[88:103], v[28:31], v[64:71], v4
  v_exp_f32 v43, v43
  v_exp_f32 v44, v44
  v_mfma_f32_32x32x16_bf16 v[56:71], v[20:23], v[220:223], v[120:135]
  v_exp_f32 v45, v45
  v_exp_f32 v46, v46
  v_exp_f32 v47, v47
  ds_read_b128 v[16:19], v2 offset:30720
  s_mov_b64 exec, s[56:57]
  ds_read_b128 v[24:27], v3 offset:30720
  ds_read_b128 v[28:31], v3 offset:31232
  s_mov_b64 exec, -1
  v_exp_f32 v48, v48
  v_exp_f32 v49, v49
  v_exp_f32 v50, v50
  v_smfmac_f32_32x32x32_bf16 v[72:87], v[32:35], v[40:47], v4
  v_exp_f32 v51, v51
  v_exp_f32 v52, v52
  v_exp_f32 v53, v53
  v_exp_f32 v54, v54
  v_exp_f32 v55, v55
  v_exp_f32 v56, v56
  v_exp_f32 v57, v57
  v_exp_f32 v58, v58
  v_smfmac_f32_32x32x32_bf16 v[72:87], v[36:39], v[48:55], v4
  v_exp_f32 v59, v59
  v_exp_f32 v60, v60
  s_waitcnt lgkmcnt(0)
  v_mfma_f32_32x32x16_bf16 v[40:55], v[16:19], v[216:219], v[104:119]
  v_exp_f32 v61, v61
  v_exp_f32 v62, v62
  v_exp_f32 v63, v63
  v_exp_f32 v64, v64
  v_exp_f32 v65, v65
  v_exp_f32 v66, v66
  v_smfmac_f32_32x32x32_bf16 v[88:103], v[32:35], v[56:63], v4
  v_exp_f32 v67, v67
  v_exp_f32 v68, v68
  v_exp_f32 v69, v69
  v_exp_f32 v70, v70
  v_exp_f32 v71, v71
  v_exp_f32 v40, v40
  v_exp_f32 v41, v41
  v_exp_f32 v42, v42
  v_smfmac_f32_32x32x32_bf16 v[88:103], v[36:39], v[64:71], v4
  v_exp_f32 v43, v43
  v_exp_f32 v44, v44
  v_mfma_f32_32x32x16_bf16 v[56:71], v[16:19], v[220:223], v[120:135]
  v_exp_f32 v45, v45
  v_exp_f32 v46, v46
  v_exp_f32 v47, v47
  ds_read_b128 v[20:23], v2 offset:31744
  s_mov_b64 exec, s[56:57]
  ds_read_b128 v[32:35], v3 offset:31744
  ds_read_b128 v[36:39], v3 offset:32256
  s_mov_b64 exec, -1
  v_exp_f32 v48, v48
  v_exp_f32 v49, v49
  v_exp_f32 v50, v50
  v_smfmac_f32_32x32x32_bf16 v[72:87], v[24:27], v[40:47], v4
  v_exp_f32 v51, v51
  v_exp_f32 v52, v52
  v_exp_f32 v53, v53
  v_exp_f32 v54, v54
  v_exp_f32 v55, v55
  v_exp_f32 v56, v56
  v_exp_f32 v57, v57
  v_exp_f32 v58, v58
  v_smfmac_f32_32x32x32_bf16 v[72:87], v[28:31], v[48:55], v4
  v_exp_f32 v59, v59
  v_exp_f32 v60, v60
  s_waitcnt lgkmcnt(0)
  v_mfma_f32_32x32x16_bf16 v[40:55], v[20:23], v[216:219], v[104:119]
  v_exp_f32 v61, v61
  v_exp_f32 v62, v62
  v_exp_f32 v63, v63
  v_exp_f32 v64, v64
  v_exp_f32 v65, v65
  v_exp_f32 v66, v66
  v_smfmac_f32_32x32x32_bf16 v[88:103], v[24:27], v[56:63], v4
  v_exp_f32 v67, v67
  v_exp_f32 v68, v68
  v_exp_f32 v69, v69
  v_exp_f32 v70, v70
  v_exp_f32 v71, v71
  v_exp_f32 v40, v40
  v_exp_f32 v41, v41
  v_exp_f32 v42, v42
  v_smfmac_f32_32x32x32_bf16 v[88:103], v[28:31], v[64:71], v4
  v_exp_f32 v43, v43
  v_exp_f32 v44, v44
  v_mfma_f32_32x32x16_bf16 v[56:71], v[20:23], v[220:223], v[120:135]
  v_exp_f32 v45, v45
  v_exp_f32 v46, v46
  v_exp_f32 v47, v47
  ds_read_b128 v[16:19], v2 offset:32768
  s_mov_b64 exec, s[56:57]
  ds_read_b128 v[24:27], v3 offset:32768
  ds_read_b128 v[28:31], v3 offset:33280
  s_mov_b64 exec, -1
  v_exp_f32 v48, v48
  v_exp_f32 v49, v49
  v_exp_f32 v50, v50
  v_smfmac_f32_32x32x32_bf16 v[72:87], v[32:35], v[40:47], v4
  v_exp_f32 v51, v51
  v_exp_f32 v52, v52
  v_exp_f32 v53, v53
  v_exp_f32 v54, v54
  v_exp_f32 v55, v55
  v_exp_f32 v56, v56
  v_exp_f32 v57, v57
  v_exp_f32 v58, v58
  v_smfmac_f32_32x32x32_bf16 v[72:87], v[36:39], v[48:55], v4
  v_exp_f32 v59, v59
  v_exp_f32 v60, v60
  s_waitcnt lgkmcnt(0)
  v_mfma_f32_32x32x16_bf16 v[40:55], v[16:19], v[216:219], v[104:119]
  v_exp_f32 v61, v61
  v_exp_f32 v62, v62
  v_exp_f32 v63, v63
  v_exp_f32 v64, v64
  v_exp_f32 v65, v65
  v_exp_f32 v66, v66
  v_smfmac_f32_32x32x32_bf16 v[88:103], v[32:35], v[56:63], v4
  v_exp_f32 v67, v67
  v_exp_f32 v68, v68
  v_exp_f32 v69, v69
  v_exp_f32 v70, v70
  v_exp_f32 v71, v71
  s_branch L_mdone
L_rloop0:
  s_mov_b32 s53, 0
L_rloop:
  v_exp_f32 v40, v40
  v_exp_f32 v41, v41
  v_exp_f32 v42, v42
  v_smfmac_f32_32x32x32_bf16 v[88:103], v[36:39], v[64:71], v4
  v_exp_f32 v43, v43
  v_exp_f32 v44, v44
  v_mfma_f32_32x32x16_bf16 v[56:71], v[16:19], v[220:223], v[120:135]
  v_exp_f32 v45, v45
  v_exp_f32 v46, v46
  v_exp_f32 v47, v47
  ds_read_b128 v[20:23], v2 offset:1024
  s_mov_b64 exec, s[56:57]
  ds_read_b128 v[32:35], v3 offset:1024
  ds_read_b128 v[36:39], v3 offset:1536
  s_mov_b64 exec, -1
  v_exp_f32 v48, v48
  v_exp_f32 v49, v49
  v_exp_f32 v50, v50
  v_smfmac_f32_32x32x32_bf16 v[72:87], v[24:27], v[40:47], v4
  v_exp_f32 v51, v51
  v_exp_f32 v52, v52
  v_exp_f32 v53, v53
  v_exp_f32 v54, v54
  v_exp_f32 v55, v55
  v_exp_f32 v56, v56
  v_exp_f32 v57, v57
  v_exp_f32 v58, v58
  v_smfmac_f32_32x32x32_bf16 v[72:87], v[28:31], v[48:55], v4
  v_exp_f32 v59, v59
  v_exp_f32 v60, v60
  s_waitcnt lgkmcnt(0)
  v_mfma_f32_32x32x16_bf16 v[40:55], v[20:23], v[216:219], v[104:119]
  v_exp_f32 v61, v61
  v_exp_f32 v62, v62
  v_exp_f32 v63, v63
  v_exp_f32 v64, v64
  v_exp_f32 v65, v65
  v_exp_f32 v66, v66
  v_smfmac_f32_32x32x32_bf16 v[88:103], v[24:27], v[56:63], v4
  v_exp_f32 v67, v67
  v_exp_f32 v68, v68
  v_exp_f32 v69, v69
  v_exp_f32 v70, v70
  v_exp_f32 v71, v71
  v_exp_f32 v40, v40
  v_exp_f32 v41, v41
  v_exp_f32 v42, v42
  v_smfmac_f32_32x32x32_bf16 v[88:103], v[28:31], v[64:71], v4
  v_exp_f32 v43, v43
  v_exp_f32 v44, v44
  v_mfma_f32_32x32x16_bf16 v[56:71], v[20:23], v[220:223], v[120:135]
  v_exp_f32 v45, v45
  v_exp_f32 v46, v46
  v_exp_f32 v47, v47
  ds_read_b128 v[16:19], v2 offset:2048
  s_mov_b64 exec, s[56:57]
  ds_read_b128 v[24:27], v3 offset:2048
  ds_read_b128 v[28:31], v3 offset:2560
  s_mov_b64 exec, -1
  v_exp_f32 v48, v48
  v_exp_f32 v49, v49
  v_exp_f32 v50, v50
  v_smfmac_f32_32x32x32_bf16 v[72:87], v[32:35], v[40:47], v4
  v_exp_f32 v51, v51
  v_exp_f32 v52, v52
  v_exp_f32 v53, v53
  v_exp_f32 v54, v54
  v_exp_f32 v55, v55
  v_exp_f32 v56, v56
  v_exp_f32 v57, v57
  v_exp_f32 v58, v58
  v_smfmac_f32_32x32x32_bf16 v[72:87], v[36:39], v[48:55], v4
  v_exp_f32 v59, v59
  v_exp_f32 v60, v60
  s_waitcnt lgkmcnt(0)
  v_mfma_f32_32x32x16_bf16 v[40:55], v[16:19], v[216:219], v[104:119]
  v_exp_f32 v61, v61
  v_exp_f32 v62, v62
  v_exp_f32 v63, v63
  v_exp_f32 v64, v64
  v_exp_f32 v65, v65
  v_exp_f32 v66, v66
  v_smfmac_f32_32x32x32_bf16 v[88:103], v[32:35], v[56:63], v4
  v_exp_f32 v67, v67
  v_exp_f32 v68, v68
  v_exp_f32 v69, v69
  v_exp_f32 v70, v70
  v_exp_f32 v71, v71
  v_add_u32 v2, 2048, v2
  v_add_u32 v3, 2048, v3
  s_add_u32 s53, s53, 1
  s_cmp_lt_u32 s53, 16
  s_cbranch_scc1 L_rloop
L_mdone:
  s_setprio 0
  v_smfmac_f32_32x32x32_bf16 v[88:103], v[36:39], v[64:71], v4
  s_mul_i32 s29, s24, 2560
  s_add_u32 s29, s29, 131072
  s_xor_b32 s30, s24, 4
  s_mul_i32 s30, s30, 2560
  s_add_u32 s30, s30, 131072
  v_add_u32 v5, s29, v255
  v_lshlrev_b32 v6, 3, v0
  v_add_u32 v6, s29, v6
  v_add_u32 v165, s30, v255
  v_lshlrev_b32 v166, 3, v0
  v_add_u32 v166, s30, v166
  s_nop 3
  s_cmp_lg_u32 s54, 0
  s_cbranch_scc1 L_nochk
  v_mul_f32 v136, 0, v72
  v_fma_f32 v136, v73, 0, v136
  v_fma_f32 v136, v74, 0, v136
  v_fma_f32 v136, v75, 0, v136
  v_fma_f32 v136, v76, 0, v136
  v_fma_f32 v136, v77, 0, v136
  v_fma_f32 v136, v78, 0, v136
  v_fma_f32 v136, v79, 0, v136
  v_fma_f32 v136, v88, 0, v136
  v_fma_f32 v136, v89, 0, v136
  v_fma_f32 v136, v90, 0, v136
  v_fma_f32 v136, v91, 0, v136
  v_fma_f32 v136, v92, 0, v136
  v_fma_f32 v136, v93, 0, v136
  v_fma_f32 v136, v94, 0, v136
  v_fma_f32 v136, v95, 0, v136
  v_max_f32 v137, v80, v96
  v_add_f32 v138, v80, v96
  v_add_f32 v137, v137, v136
  v_mul_f32 v138, 0, v138
  v_add_f32 v137, v137, v138
  v_mov_b32 v139, 0x4e800000
  v_mov_b32 v167, 151552
  v_cmp_nle_f32 vcc, v137, v139
  v_mov_b32 v139, 1
  s_nop 3
  s_cmp_eq_u64 vcc, 0
  s_cbranch_scc1 L_nochk
  ds_write_b32 v167, v139
L_nochk:
  s_cmp_eq_u32 s26, 0
  s_cbranch_scc1 L_noswap
  v_swap_b32 v72, v88
  v_swap_b32 v73, v89
  v_swap_b32 v74, v90
  v_swap_b32 v75, v91
  v_swap_b32 v76, v92
  v_swap_b32 v77, v93
  v_swap_b32 v78, v94
  v_swap_b32 v79, v95
  v_swap_b32 v80, v96
  v_swap_b32 v104, v120
L_noswap:
  v_mov_b32 v136, v96
  v_mov_b32 v137, v120
  ds_write_b128 v5, v[88:91]
  ds_write_b128 v5, v[92:95] offset:1024
  ds_write_b64 v6, v[136:137] offset:2048
  s_cmp_eq_u32 s26, 0
  s_cbranch_scc1 L_cp_17
  s_cmp_lg_u32 s63, 11
  s_cbranch_scc1 L_ns_18
  s_mov_b32 s60, s61
  s_lshl_b32 s67, s25, 15
  s_mov_b32 s4, s40
  s_mov_b32 s5, s41
  s_mov_b32 s6, 524288
L_ns_18:
  s_cmp_eq_u32 s63, 10
  s_cselect_b32 s43, s25, 0
  s_and_b32 s43, s43, 1
  s_lshl_b32 s43, s43, 11
  s_sub_u32 s43, s60, s43
  s_and_b32 s64, s63, 3
  s_lshl_b32 s64, s64, 13
  s_add_u32 s63, s63, 1
  s_add_u32 s33, s64, s68
  s_mov_b32 m0, s33
  s_add_u32 s33, s33, 1024
  buffer_load_dwordx4 v224, s[4:7], s67 offen lds
  s_add_u32 s67, s67, 8192
  s_mov_b32 m0, s33
  s_add_u32 s33, s33, 1024
  buffer_load_dwordx4 v224, s[4:7], s67 offen lds
  s_add_u32 s67, s67, 8192
  s_mov_b32 m0, s33
  s_add_u32 s33, s33, 1024
  buffer_load_dwordx4 v224, s[4:7], s67 offen lds
  s_add_u32 s67, s67, 8192
  s_mov_b32 m0, s33
  s_add_u32 s33, s33, 1024
  buffer_load_dwordx4 v224, s[4:7], s67 offen lds
  s_add_u32 s67, s67, 106496
L_cp_17:
  s_cmp_lg_u32 s24, 0
  s_cbranch_scc1 L_pok_19
  s_mov_b32 s66, 0
  s_waitcnt vmcnt(0)
L_psp_20:
  v_cmp_ne_u32 vcc, s3, v254
  s_nop 4
  s_cmp_eq_u64 vcc, 0
  s_cbranch_scc1 L_pok_19
  s_add_u32 s66, s66, 1
  s_cmp_gt_u32 s66, 0x8000
  s_cbranch_scc1 L_bail
  s_sleep 1
  global_load_dword v254, v7, s[20:21] sc1
  s_waitcnt vmcnt(0)
  s_branch L_psp_20
L_pok_19:
  s_waitcnt lgkmcnt(0)
  s_barrier
  v_mov_b32 v167, 151552
  ds_read_b32 v167, v167
  ds_read_b64 v[136:137], v166 offset:2048
  ds_read_b128 v[88:91], v165
  ds_read_b128 v[92:95], v165 offset:1024
  s_cmp_eq_u32 s26, 0
  s_cbranch_scc1 L_cp_21
  s_add_u32 m0, s64, s62
  s_nop 0
  buffer_load_dwordx4 v255, s[20:23], s60 offen offset:0 sc1 lds
  buffer_load_dwordx4 v255, s[20:23], s60 offen offset:1024 sc1 lds
  buffer_load_dwordx4 v255, s[20:23], s43 offen offset:2048 sc1 lds
  buffer_load_dwordx4 v255, s[20:23], s43 offen offset:3072 sc1 lds
  s_add_u32 s60, s60, 8192
L_cp_21:
  s_waitcnt lgkmcnt(3)
  v_readfirstlane_b32 s29, v167
  s_cmp_lg_u32 s54, 0
  s_cbranch_scc1 L_ok
  s_nop 2
  s_cmp_eq_u32 s29, 0
  s_cbranch_scc1 L_ok
  s_mov_b32 s54, 1
  s_waitcnt vmcnt(0) lgkmcnt(0)
  s_barrier
  s_lshl_b32 s33, s49, 16
  s_lshr_b32 s29, s24, 1
  s_and_b32 s29, s29, 1
  s_and_b32 s30, s24, 1
  s_lshl_b32 s30, s30, 2
  s_lshl_b32 s31, s26, 5
  s_add_u32 s30, s30, s31
  s_lshl_b32 s30, s30, 10
  s_lshl_b32 s31, s29, 16
  s_add_u32 s52, s31, s30
  s_lshl_b32 s31, s29, 21
  s_add_u32 s51, s31, s30
  s_add_u32 s51, s51, s33
  s_add_u32 s51, s51, 2097152
  s_mov_b32 m0, s52
  s_add_u32 s52, s52, 8192
  buffer_load_dwordx4 v255, s[20:23], s51 offen offset:0 sc1 lds
  buffer_load_dwordx4 v255, s[20:23], s51 offen offset:1024 sc1 lds
  buffer_load_dwordx4 v255, s[20:23], s51 offen offset:2048 sc1 lds
  buffer_load_dwordx4 v255, s[20:23], s51 offen offset:3072 sc1 lds
  s_add_u32 s51, s51, 8192
  s_mov_b32 m0, s52
  s_add_u32 s52, s52, 8192
  buffer_load_dwordx4 v255, s[20:23], s51 offen offset:0 sc1 lds
  buffer_load_dwordx4 v255, s[20:23], s51 offen offset:1024 sc1 lds
  buffer_load_dwordx4 v255, s[20:23], s51 offen offset:2048 sc1 lds
  buffer_load_dwordx4 v255, s[20:23], s51 offen offset:3072 sc1 lds
  s_add_u32 s51, s51, 8192
  s_mov_b32 m0, s52
  s_add_u32 s52, s52, 8192
  buffer_load_dwordx4 v255, s[20:23], s51 offen offset:0 sc1 lds
  buffer_load_dwordx4 v255, s[20:23], s51 offen offset:1024 sc1 lds
  buffer_load_dwordx4 v255, s[20:23], s51 offen offset:2048 sc1 lds
  buffer_load_dwordx4 v255, s[20:23], s51 offen offset:3072 sc1 lds
  s_add_u32 s51, s51, 8192
  s_mov_b32 m0, s52
  s_add_u32 s52, s52, 8192
  buffer_load_dwordx4 v255, s[20:23], s51 offen offset:0 sc1 lds
  buffer_load_dwordx4 v255, s[20:23], s51 offen offset:1024 sc1 lds
  buffer_load_dwordx4 v255, s[20:23], s51 offen offset:2048 sc1 lds
  buffer_load_dwordx4 v255, s[20:23], s51 offen offset:3072 sc1 lds
  s_add_u32 s51, s51, 8192
  v_lshrrev_b32 v165, 3, v0
  v_lshrrev_b32 v166, 4, v0
  v_and_b32 v166, 1, v166
  v_lshlrev_b32 v166, 2, v166
  v_and_b32 v167, 7, v0
  v_xor_b32 v166, v166, v167
  v_lshlrev_b32 v166, 4, v166
  v_lshl_add_u32 v224, v165, 10, v166
  s_lshl_b32 s29, s59, 7
  v_add_u32 v224, s29, v224
  s_mov_b32 s16, s36
  s_mov_b32 s17, s37
  s_mov_b32 s18, 2097152
  s_mov_b32 s4, s38
  s_mov_b32 s5, s39
  s_mov_b32 s6, 1409024
  s_mov_b32 s7, 0x20000
  s_lshr_b32 s29, s25, 1
  s_lshl_b32 s30, s58, 1
  s_add_u32 s30, s30, s29
  s_mul_i32 s31, s30, 86
  s_and_b32 s32, s25, 1
  s_lshl_b32 s32, s32, 2
  s_add_u32 s31, s31, s32
  s_lshl_b32 s31, s31, 10
  s_add_u32 s60, s31, 6291456
  s_lshl_b32 s30, s30, 5
  s_add_u32 s30, s30, s32
  s_lshl_b32 s30, s30, 10
  s_add_u32 s61, s30, 11927552
  s_lshl_b32 s29, s29, 15
  s_lshl_b32 s32, s32, 10
  s_add_u32 s62, s29, s32
  s_add_u32 s68, s62, 65536
  s_lshl_b32 s67, s25, 15
  s_mov_b32 s63, 0
  v_mov_b32 v72, 0
  v_mov_b32 v73, 0
  v_mov_b32 v74, 0
  v_mov_b32 v75, 0
  v_mov_b32 v76, 0
  v_mov_b32 v77, 0
  v_mov_b32 v78, 0
  v_mov_b32 v79, 0
  v_mov_b32 v80, 0
  v_mov_b32 v81, 0
  v_mov_b32 v82, 0
  v_mov_b32 v83, 0
  v_mov_b32 v84, 0
  v_mov_b32 v85, 0
  v_mov_b32 v86, 0
  v_mov_b32 v87, 0
  v_mov_b32 v88, 0
  v_mov_b32 v89, 0
  v_mov_b32 v90, 0
  v_mov_b32 v91, 0
  v_mov_b32 v92, 0
  v_mov_b32 v93, 0
  v_mov_b32 v94, 0
  v_mov_b32 v95, 0
  v_mov_b32 v96, 0
  v_mov_b32 v97, 0
  v_mov_b32 v98, 0
  v_mov_b32 v99, 0
  v_mov_b32 v100, 0
  v_mov_b32 v101, 0
  v_mov_b32 v102, 0
  v_mov_b32 v103, 0
  v_mov_b32 v64, 0
  v_mov_b32 v65, 0
  v_mov_b32 v66, 0
  v_mov_b32 v67, 0
  v_mov_b32 v68, 0
  v_mov_b32 v69, 0
  v_mov_b32 v70, 0
  v_mov_b32 v71, 0
  s_waitcnt vmcnt(0)
  s_barrier
  s_branch L_redo
L_ok:
  s_waitcnt lgkmcnt(2)
  v_min_f32 v138, v137, v104
  v_sub_f32 v139, v138, v104
  v_sub_f32 v140, v138, v137
  v_exp_f32 v139, v139
  v_exp_f32 v140, v140
  s_nop 0
  v_mul_f32 v141, v139, v80
  v_fma_f32 v141, v140, v136, v141
  v_rcp_f32 v141, v141
  s_nop 0
  v_mul_f32 v139, v139, v141
  v_mul_f32 v140, v140, v141
  s_waitcnt lgkmcnt(0)
  v_mul_f32 v72, v72, v139
  v_mul_f32 v73, v73, v139
  v_mul_f32 v74, v74, v139
  v_mul_f32 v75, v75, v139
  v_mul_f32 v76, v76, v139
  v_mul_f32 v77, v77, v139
  v_mul_f32 v78, v78, v139
  v_mul_f32 v79, v79, v139
  v_fma_f32 v72, v88, v140, v72
  v_fma_f32 v73, v89, v140, v73
  v_fma_f32 v74, v90, v140, v74
  v_fma_f32 v75, v91, v140, v75
  v_fma_f32 v76, v92, v140, v76
  v_fma_f32 v77, v93, v140, v77
  v_fma_f32 v78, v94, v140, v78
  v_fma_f32 v79, v95, v140, v79
  v_cvt_pk_bf16_f32 v144, v72, v73
  v_cvt_pk_bf16_f32 v145, v74, v75
  v_cvt_pk_bf16_f32 v146, v76, v77
  v_cvt_pk_bf16_f32 v147, v78, v79
  s_add_u32 s29, s55, s26
  s_lshl_b32 s29, s29, 5
  s_add_u32 s29, s29, s49
  s_lshl_b32 s29, s29, 10
  s_add_u32 s29, s29, 11927552
  buffer_store_dwordx4 v[144:147], v255, s[20:23], s29 offen sc1
  s_cmp_eq_u32 s26, 0
  s_cbranch_scc0 L_cprod
  s_lshr_b32 s29, s24, 1
  s_lshl_b32 s30, s58, 1
  s_add_u32 s30, s30, s29
  s_lshl_b32 s30, s30, 15
  s_and_b32 s31, s24, 1
  s_lshl_b32 s31, s31, 6
  s_lshl_b32 s32, s59, 7
  s_add_u32 s30, s30, s31
  s_add_u32 s34, s30, s32
  v_and_b32 v8, 31, v0
  v_lshlrev_b32 v8, 10, v8
  v_lshrrev_b32 v6, 5, v0
  v_lshl_add_u32 v8, v6, 4, v8
  buffer_load_dwordx4 v[96:99], v8, s[8:11], s34 offen
  buffer_load_dwordx4 v[100:103], v8, s[8:11], s34 offen offset:32
  s_lshl_b32 s29, s29, 15
  v_add_u32 v227, s29, v255
  v_lshrrev_b32 v5, 5, v0
  v_lshlrev_b32 v5, 2, v5
  v_bfe_u32 v6, v0, 2, 2
  v_add_u32 v5, v5, v6
  v_lshlrev_b32 v5, 7, v5
  v_lshrrev_b32 v6, 1, v6
  s_and_b32 s30, s24, 1
  v_xor_b32 v6, s30, v6
  v_lshl_add_u32 v5, v6, 6, v5
  v_bfe_u32 v6, v0, 4, 1
  v_lshl_add_u32 v5, v6, 5, v5
  v_and_b32 v6, 3, v0
  v_lshl_add_u32 v5, v6, 3, v5
  v_add_u32 v228, 65536, v5
  v_mov_b32 v225, v227
  v_mov_b32 v226, v228
  s_lshr_b32 s29, s58, 2
  s_lshl_b32 s29, s29, 7
  s_add_u32 s29, s29, 14032896
  v_and_b32 v7, 31, v0
  v_lshl_add_u32 v7, v7, 2, s29
  v_mov_b32 v16, 0
  v_mov_b32 v17, 0
  v_mov_b32 v18, 0
  v_mov_b32 v19, 0
  v_mov_b32 v20, 0
  v_mov_b32 v21, 0
  v_mov_b32 v22, 0
  v_mov_b32 v23, 0
  v_mov_b32 v24, 0
  v_mov_b32 v25, 0
  v_mov_b32 v26, 0
  v_mov_b32 v27, 0
  v_mov_b32 v28, 0
  v_mov_b32 v29, 0
  v_mov_b32 v30, 0
  v_mov_b32 v31, 0
  s_mov_b32 s42, 0
  s_mov_b32 s65, 0
  s_barrier
  ds_read_b128 v[32:35], v225 offset:0
  ds_read_b64_tr_b16 v[64:65], v226 offset:0
  ds_read_b64_tr_b16 v[66:67], v226 offset:1024
  ds_read_b128 v[36:39], v225 offset:1024
  ds_read_b64_tr_b16 v[68:69], v226 offset:2048
  ds_read_b64_tr_b16 v[70:71], v226 offset:3072
  ds_read_b128 v[40:43], v225 offset:2048
  ds_read_b64_tr_b16 v[72:73], v226 offset:4096
  ds_read_b64_tr_b16 v[74:75], v226 offset:5120
L_cloop:
  s_cmp_lg_u32 s65, 0
  s_cbranch_scc1 L_c_n4
  s_waitcnt vmcnt(2)
L_c_n4:
  s_add_u32 s29, s65, 1
  s_and_b32 s29, s29, 3
  s_lshl_b32 s29, s29, 13
  v_add_u32 v229, s29, v227
  v_add_u32 v230, s29, v228
  s_cmp_lg_u32 s24, 0
  s_cbranch_scc1 L_c_n2
  s_cmp_eq_u32 s42, 1
  s_cbranch_scc1 L_c_n2
  s_cmp_lt_u32 s65, 3
  s_cbranch_scc1 L_c_n2
  s_cmp_eq_u32 s65, 3
  s_cbranch_scc1 L_c_np
  s_waitcnt vmcnt(0)
  v_cmp_ne_u32 vcc, s3, v254
  s_nop 4
  s_cmp_eq_u64 vcc, 0
  s_cbranch_scc0 L_c_nc
  s_mov_b32 s42, 1
  s_branch L_c_n2
L_c_nc:
  s_cmp_lt_u32 s65, 8
  s_cbranch_scc1 L_c_np
  s_cmp_lg_u32 s24, 0
  s_cbranch_scc1 L_pok_22
  s_mov_b32 s66, 0
  s_waitcnt vmcnt(0)
L_psp_23:
  v_cmp_ne_u32 vcc, s3, v254
  s_nop 4
  s_cmp_eq_u64 vcc, 0
  s_cbranch_scc1 L_pok_22
  s_add_u32 s66, s66, 1
  s_cmp_gt_u32 s66, 0x8000
  s_cbranch_scc1 L_bail
  s_sleep 1
  global_load_dword v254, v7, s[20:21] sc1
  s_waitcnt vmcnt(0)
  s_branch L_psp_23
L_pok_22:
  s_mov_b32 s42, 1
  s_branch L_c_n2
L_c_np:
  global_load_dword v254, v7, s[20:21] sc1
L_c_n2:
  s_barrier
  s_cmp_lg_u32 s65, 0
  s_cbranch_scc1 L_c_n1
  s_lshl_b32 s29, s50, 7
  s_lshl_b32 s30, s49, 2
  s_add_u32 s29, s29, s30
  s_add_u32 s29, s29, 14032896
  s_cmp_lg_u32 s24, 0
  s_cbranch_scc1 L_sig_24
  v_mov_b32 v5, s29
  v_mov_b32 v6, s3
  s_mov_b64 exec, 1
  global_store_dword v5, v6, s[20:21] sc1
  s_mov_b64 exec, -1
L_sig_24:
L_c_n1:
  s_waitcnt lgkmcnt(6)
  v_mfma_f32_32x32x16_bf16 v[16:31], v[64:67], v[32:35], v[16:31]
  ds_read_b128 v[44:47], v225 offset:3072
  ds_read_b64_tr_b16 v[76:77], v226 offset:6144
  ds_read_b64_tr_b16 v[78:79], v226 offset:7168
  s_waitcnt lgkmcnt(6)
  v_mfma_f32_32x32x16_bf16 v[16:31], v[68:71], v[36:39], v[16:31]
  ds_read_b128 v[48:51], v225 offset:4096
  ds_read_b64_tr_b16 v[80:81], v226 offset:32768
  ds_read_b64_tr_b16 v[82:83], v226 offset:33792
  s_waitcnt lgkmcnt(6)
  v_mfma_f32_32x32x16_bf16 v[16:31], v[72:75], v[40:43], v[16:31]
  ds_read_b128 v[52:55], v225 offset:5120
  ds_read_b64_tr_b16 v[84:85], v226 offset:34816
  ds_read_b64_tr_b16 v[86:87], v226 offset:35840
  s_waitcnt lgkmcnt(6)
  v_mfma_f32_32x32x16_bf16 v[16:31], v[76:79], v[44:47], v[16:31]
  ds_read_b128 v[56:59], v225 offset:6144
  ds_read_b64_tr_b16 v[88:89], v226 offset:36864
  ds_read_b64_tr_b16 v[90:91], v226 offset:37888
  s_waitcnt lgkmcnt(6)
  v_mfma_f32_32x32x16_bf16 v[16:31], v[80:83], v[48:51], v[16:31]
  ds_read_b128 v[60:63], v225 offset:7168
  ds_read_b64_tr_b16 v[92:93], v226 offset:38912
  ds_read_b64_tr_b16 v[94:95], v226 offset:39936
  s_waitcnt lgkmcnt(6)
  v_mfma_f32_32x32x16_bf16 v[16:31], v[84:87], v[52:55], v[16:31]
  ds_read_b128 v[32:35], v229 offset:0
  ds_read_b64_tr_b16 v[64:65], v230 offset:0
  ds_read_b64_tr_b16 v[66:67], v230 offset:1024
  s_waitcnt lgkmcnt(6)
  v_mfma_f32_32x32x16_bf16 v[16:31], v[88:91], v[56:59], v[16:31]
  ds_read_b128 v[36:39], v229 offset:1024
  ds_read_b64_tr_b16 v[68:69], v230 offset:2048
  ds_read_b64_tr_b16 v[70:71], v230 offset:3072
  s_waitcnt lgkmcnt(6)
  v_mfma_f32_32x32x16_bf16 v[16:31], v[92:95], v[60:63], v[16:31]
  ds_read_b128 v[40:43], v229 offset:2048
  ds_read_b64_tr_b16 v[72:73], v230 offset:4096
  ds_read_b64_tr_b16 v[74:75], v230 offset:5120
  v_mov_b32 v225, v229
  v_mov_b32 v226, v230
  s_add_u32 s65, s65, 1
  s_cmp_lt_u32 s65, 15
  s_cbranch_scc1 L_cloop
  s_waitcnt lgkmcnt(0)
  s_waitcnt vmcnt(0)
  s_nop 8
  v_permlane32_swap_b32 v16, v20
  v_permlane32_swap_b32 v17, v21
  v_permlane32_swap_b32 v18, v22
  v_permlane32_swap_b32 v19, v23
  v_lshlrev_b32 v104, 16, v96
  v_and_b32 v105, 0xffff0000, v96
  v_lshlrev_b32 v106, 16, v97
  v_and_b32 v107, 0xffff0000, v97
  v_lshlrev_b32 v108, 16, v98
  v_and_b32 v109, 0xffff0000, v98
  v_lshlrev_b32 v110, 16, v99
  v_and_b32 v111, 0xffff0000, v99
  v_add_f32 v16, v16, v104
  v_add_f32 v17, v17, v105
  v_add_f32 v18, v18, v106
  v_add_f32 v19, v19, v107
  v_add_f32 v20, v20, v108
  v_add_f32 v21, v21, v109
  v_add_f32 v22, v22, v110
  v_add_f32 v23, v23, v111
  v_cvt_pk_bf16_f32 v96, v16, v17
  v_cvt_pk_bf16_f32 v97, v18, v19
  v_cvt_pk_bf16_f32 v98, v20, v21
  v_cvt_pk_bf16_f32 v99, v22, v23
  buffer_store_dwordx4 v[96:99], v8, s[16:19], s34 offen offset:0
  v_permlane32_swap_b32 v24, v28
  v_permlane32_swap_b32 v25, v29
  v_permlane32_swap_b32 v26, v30
  v_permlane32_swap_b32 v27, v31
  v_lshlrev_b32 v104, 16, v100
  v_and_b32 v105, 0xffff0000, v100
  v_lshlrev_b32 v106, 16, v101
  v_and_b32 v107, 0xffff0000, v101
  v_lshlrev_b32 v108, 16, v102
  v_and_b32 v109, 0xffff0000, v102
  v_lshlrev_b32 v110, 16, v103
  v_and_b32 v111, 0xffff0000, v103
  v_add_f32 v24, v24, v104
  v_add_f32 v25, v25, v105
  v_add_f32 v26, v26, v106
  v_add_f32 v27, v27, v107
  v_add_f32 v28, v28, v108
  v_add_f32 v29, v29, v109
  v_add_f32 v30, v30, v110
  v_add_f32 v31, v31, v111
  v_cvt_pk_bf16_f32 v100, v24, v25
  v_cvt_pk_bf16_f32 v101, v26, v27
  v_cvt_pk_bf16_f32 v102, v28, v29
  v_cvt_pk_bf16_f32 v103, v30, v31
  buffer_store_dwordx4 v[100:103], v8, s[16:19], s34 offen offset:32
  s_cmp_lg_u32 s2, 0
  s_cbranch_scc1 L_cdone
  s_mov_b32 s29, 14036992
  s_cmp_lg_u32 s24, 0
  s_cbranch_scc1 L_sig_25
  v_mov_b32 v5, s29
  v_mov_b32 v6, s3
  s_mov_b64 exec, 1
  global_store_dword v5, v6, s[20:21] sc1
  s_mov_b64 exec, -1
L_sig_25:
  s_branch L_cdone
L_cprod:
  s_cmp_lg_u32 s63, 11
  s_cbranch_scc1 L_ns_26
  s_mov_b32 s60, s61
  s_lshl_b32 s67, s25, 15
  s_mov_b32 s4, s40
  s_mov_b32 s5, s41
  s_mov_b32 s6, 524288
L_ns_26:
  s_cmp_eq_u32 s63, 10
  s_cselect_b32 s43, s25, 0
  s_and_b32 s43, s43, 1
  s_lshl_b32 s43, s43, 11
  s_sub_u32 s43, s60, s43
  s_and_b32 s64, s63, 3
  s_lshl_b32 s64, s64, 13
  s_add_u32 s63, s63, 1
  s_add_u32 m0, s64, s62
  s_nop 0
  buffer_load_dwordx4 v255, s[20:23], s60 offen offset:0 sc1 lds
  buffer_load_dwordx4 v255, s[20:23], s60 offen offset:1024 sc1 lds
  buffer_load_dwordx4 v255, s[20:23], s43 offen offset:2048 sc1 lds
  buffer_load_dwordx4 v255, s[20:23], s43 offen offset:3072 sc1 lds
  s_add_u32 s60, s60, 8192
  s_add_u32 s33, s64, s68
  s_mov_b32 m0, s33
  s_add_u32 s33, s33, 1024
  buffer_load_dwordx4 v224, s[4:7], s67 offen lds
  s_add_u32 s67, s67, 8192
  s_mov_b32 m0, s33
  s_add_u32 s33, s33, 1024
  buffer_load_dwordx4 v224, s[4:7], s67 offen lds
  s_add_u32 s67, s67, 8192
  s_mov_b32 m0, s33
  s_add_u32 s33, s33, 1024
  buffer_load_dwordx4 v224, s[4:7], s67 offen lds
  s_add_u32 s67, s67, 8192
  s_mov_b32 m0, s33
  s_add_u32 s33, s33, 1024
  buffer_load_dwordx4 v224, s[4:7], s67 offen lds
  s_add_u32 s67, s67, 106496
  s_mov_b32 s65, 0
  s_waitcnt vmcnt(9)
  s_barrier
  s_cmp_lg_u32 s63, 11
  s_cbranch_scc1 L_ns_27
  s_mov_b32 s60, s61
  s_lshl_b32 s67, s25, 15
  s_mov_b32 s4, s40
  s_mov_b32 s5, s41
  s_mov_b32 s6, 524288
L_ns_27:
  s_cmp_eq_u32 s63, 10
  s_cselect_b32 s43, s25, 0
  s_and_b32 s43, s43, 1
  s_lshl_b32 s43, s43, 11
  s_sub_u32 s43, s60, s43
  s_and_b32 s64, s63, 3
  s_lshl_b32 s64, s64, 13
  s_add_u32 s63, s63, 1
  s_add_u32 m0, s64, s62
  s_nop 0
  buffer_load_dwordx4 v255, s[20:23], s60 offen offset:0 sc1 lds
  buffer_load_dwordx4 v255, s[20:23], s60 offen offset:1024 sc1 lds
  buffer_load_dwordx4 v255, s[20:23], s43 offen offset:2048 sc1 lds
  buffer_load_dwordx4 v255, s[20:23], s43 offen offset:3072 sc1 lds
  s_add_u32 s60, s60, 8192
  s_add_u32 s33, s64, s68
  s_mov_b32 m0, s33
  s_add_u32 s33, s33, 1024
  buffer_load_dwordx4 v224, s[4:7], s67 offen lds
  s_add_u32 s67, s67, 8192
  s_mov_b32 m0, s33
  s_add_u32 s33, s33, 1024
  buffer_load_dwordx4 v224, s[4:7], s67 offen lds
  s_add_u32 s67, s67, 8192
  s_mov_b32 m0, s33
  s_add_u32 s33, s33, 1024
  buffer_load_dwordx4 v224, s[4:7], s67 offen lds
  s_add_u32 s67, s67, 8192
  s_mov_b32 m0, s33
  s_add_u32 s33, s33, 1024
  buffer_load_dwordx4 v224, s[4:7], s67 offen lds
  s_add_u32 s67, s67, 106496
  s_cmp_lg_u32 s63, 11
  s_cbranch_scc1 L_ns_28
  s_mov_b32 s60, s61
  s_lshl_b32 s67, s25, 15
  s_mov_b32 s4, s40
  s_mov_b32 s5, s41
  s_mov_b32 s6, 524288
L_ns_28:
  s_cmp_eq_u32 s63, 10
  s_cselect_b32 s43, s25, 0
  s_and_b32 s43, s43, 1
  s_lshl_b32 s43, s43, 11
  s_sub_u32 s43, s60, s43
  s_and_b32 s64, s63, 3
  s_lshl_b32 s64, s64, 13
  s_add_u32 s63, s63, 1
L_ploop:
  s_waitcnt vmcnt(8)
L_pbar:
  s_barrier
  s_add_u32 m0, s64, s62
  s_nop 0
  buffer_load_dwordx4 v255, s[20:23], s60 offen offset:0 sc1 lds
  buffer_load_dwordx4 v255, s[20:23], s60 offen offset:1024 sc1 lds
  buffer_load_dwordx4 v255, s[20:23], s43 offen offset:2048 sc1 lds
  buffer_load_dwordx4 v255, s[20:23], s43 offen offset:3072 sc1 lds
  s_add_u32 s60, s60, 8192
  s_add_u32 s33, s64, s68
  s_mov_b32 m0, s33
  s_add_u32 s33, s33, 1024
  buffer_load_dwordx4 v224, s[4:7], s67 offen lds
  s_add_u32 s67, s67, 8192
  s_mov_b32 m0, s33
  s_add_u32 s33, s33, 1024
  buffer_load_dwordx4 v224, s[4:7], s67 offen lds
  s_add_u32 s67, s67, 8192
  s_mov_b32 m0, s33
  s_add_u32 s33, s33, 1024
  buffer_load_dwordx4 v224, s[4:7], s67 offen lds
  s_add_u32 s67, s67, 8192
  s_mov_b32 m0, s33
  s_add_u32 s33, s33, 1024
  buffer_load_dwordx4 v224, s[4:7], s67 offen lds
  s_add_u32 s67, s67, 106496
  s_cmp_lg_u32 s63, 11
  s_cbranch_scc1 L_ns_29
  s_mov_b32 s60, s61
  s_lshl_b32 s67, s25, 15
  s_mov_b32 s4, s40
  s_mov_b32 s5, s41
  s_mov_b32 s6, 524288
L_ns_29:
  s_cmp_eq_u32 s63, 10
  s_cselect_b32 s43, s25, 0
  s_and_b32 s43, s43, 1
  s_lshl_b32 s43, s43, 11
  s_sub_u32 s43, s60, s43
  s_and_b32 s64, s63, 3
  s_lshl_b32 s64, s64, 13
  s_add_u32 s63, s63, 1
  s_add_u32 s65, s65, 1
  s_cmp_lt_u32 s65, 12
  s_cbranch_scc1 L_ploop
  s_waitcnt vmcnt(8)
  s_barrier
  s_waitcnt vmcnt(0)
  s_barrier
  s_barrier
L_cdone:
L_bail:
L_end:
  s_endpgm
.section .rodata,"a"
.p2align 6
.amdhsa_kernel parallel_sum__mha_block__glu_gated_swiglu__prompt_kernel
  .amdhsa_next_free_vgpr 256
  .amdhsa_next_free_sgpr 100
  .amdhsa_accum_offset 256
  .amdhsa_group_segment_fixed_size 0
  .amdhsa_kernarg_size 80
  .amdhsa_user_sgpr_count 2
  .amdhsa_user_sgpr_kernarg_segment_ptr 1
  .amdhsa_system_sgpr_workgroup_id_x 1
  .amdhsa_float_denorm_mode_32 3
.end_amdhsa_kernel
```
